```python
import torch

def _softmax(x, axis=-1):
    return torch.softmax(x, dim=axis)
def _gelu(x):
    return torch.nn.functional.gelu(x, approximate="tanh")
def _silu(x):
    return torch.nn.functional.silu(x)
def _sigmoid(x):
    return torch.sigmoid(x)
def _layernorm(x, axis=-1, eps=1e-5):
    m = x.mean(dim=axis, keepdim=True)
    v = x.var(dim=axis, keepdim=True, unbiased=False)
    return (x - m) / torch.sqrt(v + eps)
def _scatter_add(tgt, idx, src, axis=0):
    return tgt.clone().index_add_(axis, idx, src)
def _segment_sum(src, seg, n):
    out = torch.zeros((n,) + src.shape[1:], dtype=src.dtype)
    return out.index_add_(0, seg, src)
def _pad(x, pw):
    flat = tuple(v for pair in reversed(pw) for v in pair)
    return torch.nn.functional.pad(x, flat)

kernel_name = 'sequential_preLN__gqa_block_cached__geglu_ffn__decode'

def setup_inputs():

    _w = (lambda a: (lambda t: t.to(torch.bfloat16) if t.is_floating_point() else t)(torch.as_tensor(a)))
    def _A_setup():
        B, Sq, D = 1, 1, 576
        Hq, Hkv, Sk, Dh = 32, 16, 65536, 128
        assert Hq % Hkv == 0, (Hq, Hkv)
        return {
            "x": _w((lambda *s: torch.randn(*s, dtype=torch.bfloat16) * 0.05)(B, Sq, D)),
            "k_cache": _w((lambda *s: torch.randn(*s, dtype=torch.bfloat16) * 3.2)(B, Hkv, Sk, Dh)),
            "v_cache": _w((lambda *s: torch.randn(*s, dtype=torch.bfloat16) * 0.4)(B, Hkv, Sk, Dh)),
            "wq": _w((lambda *s: torch.randn(*s, dtype=torch.bfloat16) * 3.2)(D, Hq * Dh) * (D ** -0.5)),
            "wo": _w((lambda *s: torch.randn(*s, dtype=torch.bfloat16) * 0.4)(Hq * Dh, D) * ((Hq * Dh) ** -0.5)),
        }
    _A_in = _A_setup()

    def _B_setup():
        B, S, D, F = 1, 1, 576, 4608
        return {
            "x": _w((lambda *s: torch.randn(*s, dtype=torch.bfloat16) * 0.05)(B, S, D)),
            "w_gate": _w((lambda *s: torch.randn(*s, dtype=torch.bfloat16) * 0.05)(D, F)),
            "w_up": _w((lambda *s: torch.randn(*s, dtype=torch.bfloat16) * 0.05)(D, F)),
            "w_down": _w((lambda *s: torch.randn(*s, dtype=torch.bfloat16) * 0.05)(F, D)),
        }
    _B_in = _B_setup()

    return {
        "A_x": _A_in["x"],
        "A_k_cache": _A_in["k_cache"],
        "A_v_cache": _A_in["v_cache"],
        "A_wq": _A_in["wq"],
        "A_wo": _A_in["wo"],
        "B_x": _B_in["x"],
        "B_w_gate": _B_in["w_gate"],
        "B_w_up": _B_in["w_up"],
        "B_w_down": _B_in["w_down"],
    }

def reference(A_x, A_k_cache, A_v_cache, A_wq, A_wo, B_x, B_w_gate, B_w_up, B_w_down):
    def _A_ref(x, k_cache, v_cache, wq, wo):
        B, Sq, D = x.shape
        Hq, Dh = 32, 128
        Hkv = k_cache.shape[1]
        rep = Hq // Hkv
        q = (lambda x, *d: x.permute(*d))((x @ wq).reshape(B, Sq, Hq, Dh), 0, 2, 1, 3)
        k = (lambda x, n, axis: torch.repeat_interleave(x, n, dim=axis))(k_cache, rep, axis=1)
        v = (lambda x, n, axis: torch.repeat_interleave(x, n, dim=axis))(v_cache, rep, axis=1)
        scores = torch.einsum("bhqd,bhkd->bhqk", q, k) * (Dh ** -0.5)
        p = _softmax(scores, axis=-1)
        o = torch.einsum("bhqk,bhkd->bhqd", p, v)
        return (lambda x, *d: x.permute(*d))(o, 0, 2, 1, 3).reshape(B, Sq, Hq * Dh) @ wo

    def _B_ref(x, w_gate, w_up, w_down):
        return (_gelu(x @ w_gate) * (x @ w_up)) @ w_down

    x = A_x
    h = x + _A_ref(_layernorm(x, axis=-1), A_k_cache, A_v_cache, A_wq, A_wo)
    h2 = h + _B_ref(_layernorm(h, axis=-1), B_w_gate, B_w_up, B_w_down)
    return h2
```

```asm
; @launch grid=(256,1,1) block=(320,1,1) lds=161536
.amdgcn_target "amdgcn-amd-amdhsa--gfx950"
.text
.globl sequential_preLN__gqa_block_cached__geglu_ffn__decode_kernel
.p2align 8
.type sequential_preLN__gqa_block_cached__geglu_ffn__decode_kernel,@function
sequential_preLN__gqa_block_cached__geglu_ffn__decode_kernel:
  s_cmp_ge_u32 s2, 256
  s_cbranch_scc1 L_end
  s_load_dwordx16 s[4:19], s[0:1], 0
  s_load_dwordx8 s[20:27], s[0:1], 64
  v_lshrrev_b32 v2, 6, v0
  v_and_b32 v1, 63, v0
  v_readfirstlane_b32 s3, v2
  s_mov_b32 s62, 0x400000
  v_lshrrev_b32 v2, 4, v1
  v_and_b32 v3, 15, v1
  s_mov_b32 s1, s2
  s_cmp_lg_u32 s3, 0
  s_cbranch_scc1 L_cons
  v_lshlrev_b32 v4, 1, v2
  v_xor_b32 v4, v4, v3
  v_lshlrev_b32 v4, 4, v4
  v_lshl_add_u32 v4, v2, 8, v4
  v_xor_b32 v5, 0x80, v4
  s_and_b32 s59, s1, 15
  s_bitcmp1_b32 s1, 4
  s_cselect_b32 s58, 1, 0
  s_xor_b32 s59, s59, s58
  s_bitcmp1_b32 s1, 5
  s_cselect_b32 s58, 2, 0
  s_xor_b32 s59, s59, s58
  s_bitcmp1_b32 s1, 6
  s_cselect_b32 s58, 4, 0
  s_xor_b32 s59, s59, s58
  s_bitcmp1_b32 s1, 7
  s_cselect_b32 s58, 8, 0
  s_xor_b32 s59, s59, s58
  s_lshr_b32 s57, s1, 4
  s_lshl_b32 s57, s57, 24
  s_bitcmp1_b32 s59, 0
  s_cselect_b32 s58, 0x80000, 0
  s_or_b32 s57, s57, s58
  s_bitcmp1_b32 s59, 1
  s_cselect_b32 s58, 0x200000, 0
  s_or_b32 s57, s57, s58
  s_bitcmp1_b32 s59, 2
  s_cselect_b32 s58, 0x400000, 0
  s_or_b32 s57, s57, s58
  s_bitcmp1_b32 s59, 3
  s_cselect_b32 s58, 0x10000, 0
  s_or_b32 s57, s57, s58
  s_mov_b32 m0, 0
  s_mov_b32 s58, 0
  s_mov_b32 s59, 4096
  s_waitcnt lgkmcnt(0)
  s_add_u32 s28, s6, s57
  s_addc_u32 s29, s7, 0
  s_mov_b32 s30, 0x970000
  s_mov_b32 s31, 0x20000
  buffer_load_dwordx4 v4, s[28:31], s58 offen offset:0 nt lds
  buffer_load_dwordx4 v5, s[28:31], s58 offen offset:1024 nt lds
  buffer_load_dwordx4 v4, s[28:31], s58 offen offset:2048 nt lds
  buffer_load_dwordx4 v5, s[28:31], s58 offen offset:3072 nt lds
  s_add_u32 m0, m0, 4096
  s_nop 0
  buffer_load_dwordx4 v4, s[28:31], s59 offen offset:0 nt lds
  buffer_load_dwordx4 v5, s[28:31], s59 offen offset:1024 nt lds
  buffer_load_dwordx4 v4, s[28:31], s59 offen offset:2048 nt lds
  buffer_load_dwordx4 v5, s[28:31], s59 offen offset:3072 nt lds
  s_or_b32 s58, s58, 0xff691c00
  s_add_u32 s58, s58, 1024
  s_and_b32 s58, s58, 0x96e000
  s_add_u32 s59, s58, 4096
  s_add_u32 m0, m0, 4096
  s_nop 0
  buffer_load_dwordx4 v4, s[28:31], s58 offen offset:0 nt lds
  buffer_load_dwordx4 v5, s[28:31], s58 offen offset:1024 nt lds
  buffer_load_dwordx4 v4, s[28:31], s58 offen offset:2048 nt lds
  buffer_load_dwordx4 v5, s[28:31], s58 offen offset:3072 nt lds
  s_add_u32 m0, m0, 4096
  s_nop 0
  buffer_load_dwordx4 v4, s[28:31], s59 offen offset:0 nt lds
  buffer_load_dwordx4 v5, s[28:31], s59 offen offset:1024 nt lds
  buffer_load_dwordx4 v4, s[28:31], s59 offen offset:2048 nt lds
  buffer_load_dwordx4 v5, s[28:31], s59 offen offset:3072 nt lds
  s_or_b32 s58, s58, 0xff691c00
  s_add_u32 s58, s58, 1024
  s_and_b32 s58, s58, 0x96e000
  s_add_u32 s59, s58, 4096
  s_add_u32 m0, m0, 4096
  s_nop 0
  buffer_load_dwordx4 v4, s[28:31], s58 offen offset:0 nt lds
  buffer_load_dwordx4 v5, s[28:31], s58 offen offset:1024 nt lds
  buffer_load_dwordx4 v4, s[28:31], s58 offen offset:2048 nt lds
  buffer_load_dwordx4 v5, s[28:31], s58 offen offset:3072 nt lds
  s_add_u32 m0, m0, 4096
  s_nop 0
  buffer_load_dwordx4 v4, s[28:31], s59 offen offset:0 nt lds
  buffer_load_dwordx4 v5, s[28:31], s59 offen offset:1024 nt lds
  buffer_load_dwordx4 v4, s[28:31], s59 offen offset:2048 nt lds
  buffer_load_dwordx4 v5, s[28:31], s59 offen offset:3072 nt lds
  s_or_b32 s58, s58, 0xff691c00
  s_add_u32 s58, s58, 1024
  s_and_b32 s58, s58, 0x96e000
  s_add_u32 s59, s58, 4096
  s_add_u32 s32, s8, s57
  s_addc_u32 s33, s9, 0
  s_mov_b32 s34, 0x970000
  s_mov_b32 s35, 0x20000
  s_and_b32 s54, s2, 7
  s_lshr_b32 s55, s2, 3
  s_mul_i32 s56, s54, 18
  s_add_u32 s56, s56, s55
  s_sub_u32 s56, s56, 14
  s_mul_i32 s57, s54, 589824
  s_lshl_b32 s61, s55, 7
  s_add_u32 s57, s57, s61
  s_sub_u32 s61, 4718592, s57
  s_add_u32 s36, s12, s57
  s_addc_u32 s37, s13, 0
  s_mov_b32 s38, s61
  s_mov_b32 s39, 0x20000
  s_lshl_b32 s57, s56, 6
  s_sub_u32 s61, 5308416, s57
  s_add_u32 s40, s16, s57
  s_addc_u32 s41, s17, 0
  s_mov_b32 s42, s61
  s_mov_b32 s43, 0x20000
  s_add_u32 s44, s18, s57
  s_addc_u32 s45, s19, 0
  s_mov_b32 s46, s61
  s_mov_b32 s47, 0x20000
  s_mul_i32 s57, s56, 36864
  s_add_u32 s48, s20, s57
  s_addc_u32 s49, s21, 0
  s_mov_b32 s50, 36864
  s_mov_b32 s51, 0x20000
  v_mov_b32 v8, 0
  v_bfe_u32 v9, v1, 0, 1
  v_lshl_or_b32 v8, v9, 23, v8
  s_bfm_b64 exec, 2, 0
  buffer_load_dword v31, v8, s[28:31], 0 offen
  buffer_load_dword v31, v8, s[32:35], 0 offen
  s_mov_b64 exec, -1
  v_lshrrev_b32 v8, 3, v1
  v_and_b32 v9, 2, v8
  v_mul_u32_u24 v8, 1152, v8
  v_and_b32 v10, 7, v1
  v_xor_b32 v9, v9, v10
  v_lshl_add_u32 v12, v9, 4, v8
  v_xor_b32 v9, 4, v9
  v_lshl_add_u32 v16, v9, 4, v8
  v_lshrrev_b32 v8, 2, v1
  v_lshrrev_b32 v9, 5, v1
  v_mul_u32_u24 v8, 9216, v8
  v_and_b32 v10, 3, v1
  v_xor_b32 v9, v9, v10
  v_lshl_add_u32 v13, v9, 4, v8
  v_xor_b32 v9, 2, v9
  v_lshl_add_u32 v17, v9, 4, v8
  v_mov_b32 v14, 0
  v_lshlrev_b32 v6, 2, v1
  v_add_u32 v6, 147456, v6
  s_lshr_b32 s97, s56, 1
  s_mul_i32 s97, s97, 0
  s_mul_i32 s52, s54, 0
  s_add_u32 s97, s97, s52
  s_and_b32 s52, s56, 1
  s_mul_i32 s52, s52, 18
  s_add_u32 s97, s97, s52
  s_and_b32 s97, s97, 0xfff
  s_mul_i32 s52, s97, 1821
  s_lshr_b32 s52, s52, 16
  s_mul_i32 s52, s52, 36
  s_sub_u32 s97, s97, s52
  s_mul_i32 s98, s55, 0
  s_and_b32 s98, s98, 62
  v_mov_b32 v22, 0
  v_mov_b32 v23, 0
  v_mov_b32 v20, 148768
  v_mov_b32 v21, 147712
  s_mov_b32 s63, 3
  s_mov_b32 s60, 1
  s_mov_b32 s57, 24576
  s_mov_b32 s61, 0
  s_barrier
ld_1:
  s_waitcnt lgkmcnt(0)
  v_readfirstlane_b32 s52, v22
  s_nop 0
  s_cmp_ge_i32 s52, s61
  s_cbranch_scc1 ldback_2
spin_3:
  ds_read_b32 v22, v21 offset:0
  s_waitcnt lgkmcnt(0)
  v_readfirstlane_b32 s52, v22
  s_nop 0
  s_cmp_ge_i32 s52, s61
  s_cbranch_scc1 done_4
  s_sub_u32 s62, s62, 1
  s_cbranch_scc1 L_end
  s_sleep 1
  s_branch spin_3
done_4:
ldback_2:
  s_mov_b32 m0, s57
  s_sub_u32 s52, s63, 17
  s_ashr_i32 s61, s52, 2
  s_add_u32 s61, s61, 1
  s_and_b32 s52, s52, 3
  s_lshl_b32 s52, s52, 8
  s_add_u32 s52, s52, 147712
  v_mov_b32 v21, s52
  ds_read_b32 v22, v21
  s_waitcnt vmcnt(18)
  buffer_load_dwordx4 v4, s[28:31], s58 offen offset:0 nt lds
  s_waitcnt vmcnt(18)
  buffer_load_dwordx4 v5, s[28:31], s58 offen offset:1024 nt lds
  s_waitcnt vmcnt(18)
  buffer_load_dwordx4 v4, s[28:31], s58 offen offset:2048 nt lds
  s_waitcnt vmcnt(18)
  buffer_load_dwordx4 v5, s[28:31], s58 offen offset:3072 nt lds
  s_add_u32 m0, m0, 4096
  s_waitcnt vmcnt(18)
  buffer_load_dwordx4 v4, s[28:31], s59 offen offset:0 nt lds
  v_mov_b32 v7, s60
  ds_write_b32 v6, v7
  s_waitcnt vmcnt(18)
  buffer_load_dwordx4 v5, s[28:31], s59 offen offset:1024 nt lds
  s_waitcnt vmcnt(18)
  buffer_load_dwordx4 v4, s[28:31], s59 offen offset:2048 nt lds
  s_waitcnt vmcnt(18)
  buffer_load_dwordx4 v5, s[28:31], s59 offen offset:3072 nt lds
  s_or_b32 s58, s58, 0xff691c00
  s_add_u32 s58, s58, 1024
  s_and_b32 s58, s58, 0x96e000
  s_add_u32 s59, s58, 4096
  s_add_u32 s57, s57, 8192
  s_cmp_ge_u32 s57, 147456
  s_cselect_b32 s57, 0, s57
  s_add_u32 s60, s60, 1
  s_add_u32 s63, s63, 1
  s_cmp_lt_u32 s63, 16
  s_cbranch_scc1 ld_1
ld_5:
  s_waitcnt lgkmcnt(0)
  v_readfirstlane_b32 s52, v22
  s_nop 0
  s_cmp_ge_i32 s52, s61
  s_cbranch_scc1 ldback_6
spin_7:
  ds_read_b32 v22, v21 offset:0
  s_waitcnt lgkmcnt(0)
  v_readfirstlane_b32 s52, v22
  s_nop 0
  s_cmp_ge_i32 s52, s61
  s_cbranch_scc1 done_8
  s_sub_u32 s62, s62, 1
  s_cbranch_scc1 L_end
  s_sleep 1
  s_branch spin_7
done_8:
ldback_6:
  s_mov_b32 m0, s57
  s_sub_u32 s52, s63, 17
  s_ashr_i32 s61, s52, 2
  s_add_u32 s61, s61, 1
  s_and_b32 s52, s52, 3
  s_lshl_b32 s52, s52, 8
  s_add_u32 s52, s52, 147712
  v_mov_b32 v21, s52
  ds_read_b32 v22, v21
  v_readfirstlane_b32 s52, v23
  ds_read_b32 v23, v20
  s_cmp_eq_u32 s52, 1
  s_cbranch_scc1 lv_10
  s_cmp_eq_u32 s52, 2
  s_cbranch_scc1 lv_11
  s_cmp_eq_u32 s52, 4
  s_cbranch_scc1 lv_12
  s_cmp_eq_u32 s52, 5
  s_cbranch_scc1 lv_13
  s_waitcnt vmcnt(20)
  buffer_load_dwordx4 v4, s[28:31], s58 offen offset:0 nt lds
  s_waitcnt vmcnt(20)
  buffer_load_dwordx4 v5, s[28:31], s58 offen offset:1024 nt lds
  s_waitcnt vmcnt(20)
  buffer_load_dwordx4 v4, s[28:31], s58 offen offset:2048 nt lds
  s_waitcnt vmcnt(20)
  buffer_load_dwordx4 v5, s[28:31], s58 offen offset:3072 nt lds
  s_add_u32 m0, m0, 4096
  s_waitcnt vmcnt(20)
  buffer_load_dwordx4 v4, s[28:31], s59 offen offset:0 nt lds
  v_mov_b32 v7, s60
  ds_write_b32 v6, v7
  s_waitcnt vmcnt(20)
  buffer_load_dwordx4 v5, s[28:31], s59 offen offset:1024 nt lds
  s_waitcnt vmcnt(20)
  buffer_load_dwordx4 v4, s[28:31], s59 offen offset:2048 nt lds
  s_waitcnt vmcnt(20)
  buffer_load_dwordx4 v5, s[28:31], s59 offen offset:3072 nt lds
  s_or_b32 s58, s58, 0xff691c00
  s_add_u32 s58, s58, 1024
  s_and_b32 s58, s58, 0x96e000
  s_add_u32 s59, s58, 4096
  s_branch lj_9
lv_10:
  s_waitcnt vmcnt(17)
  buffer_load_dwordx4 v4, s[28:31], s58 offen offset:0 nt lds
  s_waitcnt vmcnt(17)
  buffer_load_dwordx4 v5, s[28:31], s58 offen offset:1024 nt lds
  v_mov_b32 v7, s60
  ds_write_b32 v6, v7
  s_waitcnt vmcnt(17)
  buffer_load_dwordx4 v4, s[28:31], s58 offen offset:2048 nt lds
  s_waitcnt vmcnt(17)
  buffer_load_dwordx4 v5, s[28:31], s58 offen offset:3072 nt lds
  s_add_u32 m0, m0, 4096
  s_waitcnt vmcnt(17)
  buffer_load_dwordx4 v4, s[28:31], s59 offen offset:0 nt lds
  s_waitcnt vmcnt(17)
  buffer_load_dwordx4 v5, s[28:31], s59 offen offset:1024 nt lds
  s_waitcnt vmcnt(17)
  buffer_load_dwordx4 v4, s[28:31], s59 offen offset:2048 nt lds
  s_waitcnt vmcnt(17)
  buffer_load_dwordx4 v5, s[28:31], s59 offen offset:3072 nt lds
  s_or_b32 s58, s58, 0xff691c00
  s_add_u32 s58, s58, 1024
  s_and_b32 s58, s58, 0x96e000
  s_add_u32 s59, s58, 4096
  s_branch lj_9
lv_11:
  s_waitcnt vmcnt(19)
  buffer_load_dwordx4 v4, s[28:31], s58 offen offset:0 nt lds
  s_waitcnt vmcnt(19)
  buffer_load_dwordx4 v5, s[28:31], s58 offen offset:1024 nt lds
  s_waitcnt vmcnt(19)
  buffer_load_dwordx4 v4, s[28:31], s58 offen offset:2048 nt lds
  s_waitcnt vmcnt(19)
  buffer_load_dwordx4 v5, s[28:31], s58 offen offset:3072 nt lds
  v_mov_b32 v7, s60
  ds_write_b32 v6, v7
  s_add_u32 m0, m0, 4096
  s_waitcnt vmcnt(19)
  buffer_load_dwordx4 v4, s[28:31], s59 offen offset:0 nt lds
  s_waitcnt vmcnt(19)
  buffer_load_dwordx4 v5, s[28:31], s59 offen offset:1024 nt lds
  s_waitcnt vmcnt(19)
  buffer_load_dwordx4 v4, s[28:31], s59 offen offset:2048 nt lds
  s_waitcnt vmcnt(19)
  buffer_load_dwordx4 v5, s[28:31], s59 offen offset:3072 nt lds
  s_or_b32 s58, s58, 0xff691c00
  s_add_u32 s58, s58, 1024
  s_and_b32 s58, s58, 0x96e000
  s_add_u32 s59, s58, 4096
  s_branch lj_9
lv_12:
  s_waitcnt vmcnt(21)
  buffer_load_dwordx4 v4, s[28:31], s58 offen offset:0 nt lds
  s_waitcnt vmcnt(21)
  buffer_load_dwordx4 v5, s[28:31], s58 offen offset:1024 nt lds
  s_waitcnt vmcnt(21)
  buffer_load_dwordx4 v4, s[28:31], s58 offen offset:2048 nt lds
  s_waitcnt vmcnt(21)
  buffer_load_dwordx4 v5, s[28:31], s58 offen offset:3072 nt lds
  s_add_u32 m0, m0, 4096
  s_waitcnt vmcnt(21)
  buffer_load_dwordx4 v4, s[28:31], s59 offen offset:0 nt lds
  s_waitcnt vmcnt(21)
  buffer_load_dwordx4 v5, s[28:31], s59 offen offset:1024 nt lds
  v_mov_b32 v7, s60
  ds_write_b32 v6, v7
  s_waitcnt vmcnt(21)
  buffer_load_dwordx4 v4, s[28:31], s59 offen offset:2048 nt lds
  s_waitcnt vmcnt(21)
  buffer_load_dwordx4 v5, s[28:31], s59 offen offset:3072 nt lds
  s_or_b32 s58, s58, 0xff691c00
  s_add_u32 s58, s58, 1024
  s_and_b32 s58, s58, 0x96e000
  s_add_u32 s59, s58, 4096
  s_branch lj_9
lv_13:
  s_waitcnt vmcnt(23)
  buffer_load_dwordx4 v4, s[28:31], s58 offen offset:0 nt lds
  s_waitcnt vmcnt(23)
  buffer_load_dwordx4 v5, s[28:31], s58 offen offset:1024 nt lds
  s_waitcnt vmcnt(23)
  buffer_load_dwordx4 v4, s[28:31], s58 offen offset:2048 nt lds
  s_waitcnt vmcnt(23)
  buffer_load_dwordx4 v5, s[28:31], s58 offen offset:3072 nt lds
  s_add_u32 m0, m0, 4096
  s_waitcnt vmcnt(23)
  buffer_load_dwordx4 v4, s[28:31], s59 offen offset:0 nt lds
  s_waitcnt vmcnt(23)
  buffer_load_dwordx4 v5, s[28:31], s59 offen offset:1024 nt lds
  s_waitcnt vmcnt(23)
  buffer_load_dwordx4 v4, s[28:31], s59 offen offset:2048 nt lds
  s_waitcnt vmcnt(23)
  buffer_load_dwordx4 v5, s[28:31], s59 offen offset:3072 nt lds
  v_mov_b32 v7, s60
  ds_write_b32 v6, v7
  s_or_b32 s58, s58, 0xff691c00
  s_add_u32 s58, s58, 1024
  s_and_b32 s58, s58, 0x96e000
  s_add_u32 s59, s58, 4096
lj_9:
  s_add_u32 s57, s57, 8192
  s_cmp_ge_u32 s57, 147456
  s_cselect_b32 s57, 0, s57
  s_add_u32 s60, s60, 1
  s_add_u32 s63, s63, 1
  s_cmp_lt_u32 s63, 128
  s_cbranch_scc1 ld_5
  s_mov_b32 s58, 0
  s_mov_b32 s59, 4096
ld_14:
  s_waitcnt lgkmcnt(0)
  v_readfirstlane_b32 s52, v22
  s_nop 0
  s_cmp_ge_i32 s52, s61
  s_cbranch_scc1 ldback_15
spin_16:
  ds_read_b32 v22, v21 offset:0
  s_waitcnt lgkmcnt(0)
  v_readfirstlane_b32 s52, v22
  s_nop 0
  s_cmp_ge_i32 s52, s61
  s_cbranch_scc1 done_17
  s_sub_u32 s62, s62, 1
  s_cbranch_scc1 L_end
  s_sleep 1
  s_branch spin_16
done_17:
ldback_15:
  s_mov_b32 m0, s57
  s_sub_u32 s52, s63, 17
  s_ashr_i32 s61, s52, 2
  s_add_u32 s61, s61, 1
  s_and_b32 s52, s52, 3
  s_lshl_b32 s52, s52, 8
  s_add_u32 s52, s52, 147712
  v_mov_b32 v21, s52
  ds_read_b32 v22, v21
  v_readfirstlane_b32 s52, v23
  ds_read_b32 v23, v20
  s_cmp_eq_u32 s52, 1
  s_cbranch_scc1 lv_19
  s_cmp_eq_u32 s52, 2
  s_cbranch_scc1 lv_20
  s_cmp_eq_u32 s52, 4
  s_cbranch_scc1 lv_21
  s_cmp_eq_u32 s52, 5
  s_cbranch_scc1 lv_22
  s_waitcnt vmcnt(20)
  buffer_load_dwordx4 v4, s[32:35], s58 offen offset:0 nt lds
  s_waitcnt vmcnt(20)
  buffer_load_dwordx4 v5, s[32:35], s58 offen offset:1024 nt lds
  s_waitcnt vmcnt(20)
  buffer_load_dwordx4 v4, s[32:35], s58 offen offset:2048 nt lds
  s_waitcnt vmcnt(20)
  buffer_load_dwordx4 v5, s[32:35], s58 offen offset:3072 nt lds
  s_add_u32 m0, m0, 4096
  s_waitcnt vmcnt(20)
  buffer_load_dwordx4 v4, s[32:35], s59 offen offset:0 nt lds
  v_mov_b32 v7, s60
  ds_write_b32 v6, v7
  s_waitcnt vmcnt(20)
  buffer_load_dwordx4 v5, s[32:35], s59 offen offset:1024 nt lds
  s_waitcnt vmcnt(20)
  buffer_load_dwordx4 v4, s[32:35], s59 offen offset:2048 nt lds
  s_waitcnt vmcnt(20)
  buffer_load_dwordx4 v5, s[32:35], s59 offen offset:3072 nt lds
  s_or_b32 s58, s58, 0xff691c00
  s_add_u32 s58, s58, 1024
  s_and_b32 s58, s58, 0x96e000
  s_add_u32 s59, s58, 4096
  s_branch lj_18
lv_19:
  s_waitcnt vmcnt(17)
  buffer_load_dwordx4 v4, s[32:35], s58 offen offset:0 nt lds
  s_waitcnt vmcnt(17)
  buffer_load_dwordx4 v5, s[32:35], s58 offen offset:1024 nt lds
  v_mov_b32 v7, s60
  ds_write_b32 v6, v7
  s_waitcnt vmcnt(17)
  buffer_load_dwordx4 v4, s[32:35], s58 offen offset:2048 nt lds
  s_waitcnt vmcnt(17)
  buffer_load_dwordx4 v5, s[32:35], s58 offen offset:3072 nt lds
  s_add_u32 m0, m0, 4096
  s_waitcnt vmcnt(17)
  buffer_load_dwordx4 v4, s[32:35], s59 offen offset:0 nt lds
  s_waitcnt vmcnt(17)
  buffer_load_dwordx4 v5, s[32:35], s59 offen offset:1024 nt lds
  s_waitcnt vmcnt(17)
  buffer_load_dwordx4 v4, s[32:35], s59 offen offset:2048 nt lds
  s_waitcnt vmcnt(17)
  buffer_load_dwordx4 v5, s[32:35], s59 offen offset:3072 nt lds
  s_or_b32 s58, s58, 0xff691c00
  s_add_u32 s58, s58, 1024
  s_and_b32 s58, s58, 0x96e000
  s_add_u32 s59, s58, 4096
  s_branch lj_18
lv_20:
  s_waitcnt vmcnt(19)
  buffer_load_dwordx4 v4, s[32:35], s58 offen offset:0 nt lds
  s_waitcnt vmcnt(19)
  buffer_load_dwordx4 v5, s[32:35], s58 offen offset:1024 nt lds
  s_waitcnt vmcnt(19)
  buffer_load_dwordx4 v4, s[32:35], s58 offen offset:2048 nt lds
  s_waitcnt vmcnt(19)
  buffer_load_dwordx4 v5, s[32:35], s58 offen offset:3072 nt lds
  v_mov_b32 v7, s60
  ds_write_b32 v6, v7
  s_add_u32 m0, m0, 4096
  s_waitcnt vmcnt(19)
  buffer_load_dwordx4 v4, s[32:35], s59 offen offset:0 nt lds
  s_waitcnt vmcnt(19)
  buffer_load_dwordx4 v5, s[32:35], s59 offen offset:1024 nt lds
  s_waitcnt vmcnt(19)
  buffer_load_dwordx4 v4, s[32:35], s59 offen offset:2048 nt lds
  s_waitcnt vmcnt(19)
  buffer_load_dwordx4 v5, s[32:35], s59 offen offset:3072 nt lds
  s_or_b32 s58, s58, 0xff691c00
  s_add_u32 s58, s58, 1024
  s_and_b32 s58, s58, 0x96e000
  s_add_u32 s59, s58, 4096
  s_branch lj_18
lv_21:
  s_waitcnt vmcnt(21)
  buffer_load_dwordx4 v4, s[32:35], s58 offen offset:0 nt lds
  s_waitcnt vmcnt(21)
  buffer_load_dwordx4 v5, s[32:35], s58 offen offset:1024 nt lds
  s_waitcnt vmcnt(21)
  buffer_load_dwordx4 v4, s[32:35], s58 offen offset:2048 nt lds
  s_waitcnt vmcnt(21)
  buffer_load_dwordx4 v5, s[32:35], s58 offen offset:3072 nt lds
  s_add_u32 m0, m0, 4096
  s_waitcnt vmcnt(21)
  buffer_load_dwordx4 v4, s[32:35], s59 offen offset:0 nt lds
  s_waitcnt vmcnt(21)
  buffer_load_dwordx4 v5, s[32:35], s59 offen offset:1024 nt lds
  v_mov_b32 v7, s60
  ds_write_b32 v6, v7
  s_waitcnt vmcnt(21)
  buffer_load_dwordx4 v4, s[32:35], s59 offen offset:2048 nt lds
  s_waitcnt vmcnt(21)
  buffer_load_dwordx4 v5, s[32:35], s59 offen offset:3072 nt lds
  s_or_b32 s58, s58, 0xff691c00
  s_add_u32 s58, s58, 1024
  s_and_b32 s58, s58, 0x96e000
  s_add_u32 s59, s58, 4096
  s_branch lj_18
lv_22:
  s_waitcnt vmcnt(23)
  buffer_load_dwordx4 v4, s[32:35], s58 offen offset:0 nt lds
  s_waitcnt vmcnt(23)
  buffer_load_dwordx4 v5, s[32:35], s58 offen offset:1024 nt lds
  s_waitcnt vmcnt(23)
  buffer_load_dwordx4 v4, s[32:35], s58 offen offset:2048 nt lds
  s_waitcnt vmcnt(23)
  buffer_load_dwordx4 v5, s[32:35], s58 offen offset:3072 nt lds
  s_add_u32 m0, m0, 4096
  s_waitcnt vmcnt(23)
  buffer_load_dwordx4 v4, s[32:35], s59 offen offset:0 nt lds
  s_waitcnt vmcnt(23)
  buffer_load_dwordx4 v5, s[32:35], s59 offen offset:1024 nt lds
  s_waitcnt vmcnt(23)
  buffer_load_dwordx4 v4, s[32:35], s59 offen offset:2048 nt lds
  s_waitcnt vmcnt(23)
  buffer_load_dwordx4 v5, s[32:35], s59 offen offset:3072 nt lds
  v_mov_b32 v7, s60
  ds_write_b32 v6, v7
  s_or_b32 s58, s58, 0xff691c00
  s_add_u32 s58, s58, 1024
  s_and_b32 s58, s58, 0x96e000
  s_add_u32 s59, s58, 4096
lj_18:
  s_add_u32 s57, s57, 8192
  s_cmp_ge_u32 s57, 147456
  s_cselect_b32 s57, 0, s57
  s_add_u32 s60, s60, 1
  s_add_u32 s63, s63, 1
  s_cmp_lt_u32 s63, 224
  s_cbranch_scc1 ld_14
  s_sub_i32 s60, s60, 1
ld_23:
  s_waitcnt lgkmcnt(0)
  v_readfirstlane_b32 s52, v22
  s_nop 0
  s_cmp_ge_i32 s52, s61
  s_cbranch_scc1 ldback_24
spin_25:
  ds_read_b32 v22, v21 offset:0
  s_waitcnt lgkmcnt(0)
  v_readfirstlane_b32 s52, v22
  s_nop 0
  s_cmp_ge_i32 s52, s61
  s_cbranch_scc1 done_26
  s_sub_u32 s62, s62, 1
  s_cbranch_scc1 L_end
  s_sleep 1
  s_branch spin_25
done_26:
ldback_24:
  s_mov_b32 m0, s57
  s_sub_u32 s52, s63, 17
  s_ashr_i32 s61, s52, 2
  s_add_u32 s61, s61, 1
  s_and_b32 s52, s52, 3
  s_lshl_b32 s52, s52, 8
  s_add_u32 s52, s52, 147712
  v_mov_b32 v21, s52
  ds_read_b32 v22, v21
  v_readfirstlane_b32 s52, v23
  ds_read_b32 v23, v20
  s_cmp_eq_u32 s52, 1
  s_cbranch_scc1 lv_28
  s_cmp_eq_u32 s52, 2
  s_cbranch_scc1 lv_29
  s_cmp_eq_u32 s52, 4
  s_cbranch_scc1 lv_30
  s_cmp_eq_u32 s52, 5
  s_cbranch_scc1 lv_31
  s_waitcnt vmcnt(20)
  buffer_load_dwordx4 v4, s[32:35], s58 offen offset:0 nt lds
  s_waitcnt vmcnt(20)
  buffer_load_dwordx4 v5, s[32:35], s58 offen offset:1024 nt lds
  s_waitcnt vmcnt(20)
  buffer_load_dwordx4 v4, s[32:35], s58 offen offset:2048 nt lds
  s_waitcnt vmcnt(20)
  buffer_load_dwordx4 v5, s[32:35], s58 offen offset:3072 nt lds
  v_mov_b32 v7, s60
  ds_write_b32 v6, v7
  s_add_u32 m0, m0, 4096
  s_waitcnt vmcnt(20)
  buffer_load_dwordx4 v4, s[32:35], s59 offen offset:0 nt lds
  s_waitcnt vmcnt(20)
  buffer_load_dwordx4 v5, s[32:35], s59 offen offset:1024 nt lds
  s_waitcnt vmcnt(20)
  buffer_load_dwordx4 v4, s[32:35], s59 offen offset:2048 nt lds
  s_waitcnt vmcnt(20)
  buffer_load_dwordx4 v5, s[32:35], s59 offen offset:3072 nt lds
  s_or_b32 s58, s58, 0xff691c00
  s_add_u32 s58, s58, 1024
  s_and_b32 s58, s58, 0x96e000
  s_add_u32 s59, s58, 4096
  s_branch lj_27
lv_28:
  s_waitcnt vmcnt(15)
  buffer_load_dwordx4 v4, s[32:35], s58 offen offset:0 nt lds
  s_waitcnt vmcnt(15)
  buffer_load_dwordx4 v5, s[32:35], s58 offen offset:1024 nt lds
  s_waitcnt vmcnt(15)
  buffer_load_dwordx4 v4, s[32:35], s58 offen offset:2048 nt lds
  s_waitcnt vmcnt(15)
  buffer_load_dwordx4 v5, s[32:35], s58 offen offset:3072 nt lds
  v_mov_b32 v7, s60
  ds_write_b32 v6, v7
  s_add_u32 m0, m0, 4096
  s_waitcnt vmcnt(15)
  buffer_load_dwordx4 v4, s[32:35], s59 offen offset:0 nt lds
  s_waitcnt vmcnt(15)
  buffer_load_dwordx4 v5, s[32:35], s59 offen offset:1024 nt lds
  s_waitcnt vmcnt(15)
  buffer_load_dwordx4 v4, s[32:35], s59 offen offset:2048 nt lds
  s_waitcnt vmcnt(15)
  buffer_load_dwordx4 v5, s[32:35], s59 offen offset:3072 nt lds
  s_or_b32 s58, s58, 0xff691c00
  s_add_u32 s58, s58, 1024
  s_and_b32 s58, s58, 0x96e000
  s_add_u32 s59, s58, 4096
  s_branch lj_27
lv_29:
  s_waitcnt vmcnt(18)
  buffer_load_dwordx4 v4, s[32:35], s58 offen offset:0 nt lds
  s_waitcnt vmcnt(18)
  buffer_load_dwordx4 v5, s[32:35], s58 offen offset:1024 nt lds
  s_waitcnt vmcnt(18)
  buffer_load_dwordx4 v4, s[32:35], s58 offen offset:2048 nt lds
  s_waitcnt vmcnt(18)
  buffer_load_dwordx4 v5, s[32:35], s58 offen offset:3072 nt lds
  v_mov_b32 v7, s60
  ds_write_b32 v6, v7
  s_add_u32 m0, m0, 4096
  s_waitcnt vmcnt(18)
  buffer_load_dwordx4 v4, s[32:35], s59 offen offset:0 nt lds
  s_waitcnt vmcnt(18)
  buffer_load_dwordx4 v5, s[32:35], s59 offen offset:1024 nt lds
  s_waitcnt vmcnt(18)
  buffer_load_dwordx4 v4, s[32:35], s59 offen offset:2048 nt lds
  s_waitcnt vmcnt(18)
  buffer_load_dwordx4 v5, s[32:35], s59 offen offset:3072 nt lds
  s_or_b32 s58, s58, 0xff691c00
  s_add_u32 s58, s58, 1024
  s_and_b32 s58, s58, 0x96e000
  s_add_u32 s59, s58, 4096
  s_branch lj_27
lv_30:
  s_waitcnt vmcnt(23)
  buffer_load_dwordx4 v4, s[32:35], s58 offen offset:0 nt lds
  s_waitcnt vmcnt(23)
  buffer_load_dwordx4 v5, s[32:35], s58 offen offset:1024 nt lds
  s_waitcnt vmcnt(23)
  buffer_load_dwordx4 v4, s[32:35], s58 offen offset:2048 nt lds
  s_waitcnt vmcnt(23)
  buffer_load_dwordx4 v5, s[32:35], s58 offen offset:3072 nt lds
  v_mov_b32 v7, s60
  ds_write_b32 v6, v7
  s_add_u32 m0, m0, 4096
  s_waitcnt vmcnt(23)
  buffer_load_dwordx4 v4, s[32:35], s59 offen offset:0 nt lds
  s_waitcnt vmcnt(23)
  buffer_load_dwordx4 v5, s[32:35], s59 offen offset:1024 nt lds
  s_waitcnt vmcnt(23)
  buffer_load_dwordx4 v4, s[32:35], s59 offen offset:2048 nt lds
  s_waitcnt vmcnt(23)
  buffer_load_dwordx4 v5, s[32:35], s59 offen offset:3072 nt lds
  s_or_b32 s58, s58, 0xff691c00
  s_add_u32 s58, s58, 1024
  s_and_b32 s58, s58, 0x96e000
  s_add_u32 s59, s58, 4096
  s_branch lj_27
lv_31:
  s_waitcnt vmcnt(27)
  buffer_load_dwordx4 v4, s[32:35], s58 offen offset:0 nt lds
  s_waitcnt vmcnt(27)
  buffer_load_dwordx4 v5, s[32:35], s58 offen offset:1024 nt lds
  s_waitcnt vmcnt(27)
  buffer_load_dwordx4 v4, s[32:35], s58 offen offset:2048 nt lds
  s_waitcnt vmcnt(27)
  buffer_load_dwordx4 v5, s[32:35], s58 offen offset:3072 nt lds
  v_mov_b32 v7, s60
  ds_write_b32 v6, v7
  s_add_u32 m0, m0, 4096
  s_waitcnt vmcnt(27)
  buffer_load_dwordx4 v4, s[32:35], s59 offen offset:0 nt lds
  s_waitcnt vmcnt(27)
  buffer_load_dwordx4 v5, s[32:35], s59 offen offset:1024 nt lds
  s_waitcnt vmcnt(27)
  buffer_load_dwordx4 v4, s[32:35], s59 offen offset:2048 nt lds
  s_waitcnt vmcnt(27)
  buffer_load_dwordx4 v5, s[32:35], s59 offen offset:3072 nt lds
  s_or_b32 s58, s58, 0xff691c00
  s_add_u32 s58, s58, 1024
  s_and_b32 s58, s58, 0x96e000
  s_add_u32 s59, s58, 4096
lj_27:
  s_add_u32 s57, s57, 8192
  s_cmp_ge_u32 s57, 147456
  s_cselect_b32 s57, 0, s57
  s_add_u32 s60, s60, 1
  s_add_u32 s63, s63, 1
  s_cmp_lt_u32 s63, 254
  s_cbranch_scc1 ld_23
  s_sub_i32 s60, s60, 0
ld_32:
  s_waitcnt lgkmcnt(0)
  v_readfirstlane_b32 s52, v22
  s_nop 0
  s_cmp_ge_i32 s52, s61
  s_cbranch_scc1 ldback_33
spin_34:
  ds_read_b32 v22, v21 offset:0
  s_waitcnt lgkmcnt(0)
  v_readfirstlane_b32 s52, v22
  s_nop 0
  s_cmp_ge_i32 s52, s61
  s_cbranch_scc1 done_35
  s_sub_u32 s62, s62, 1
  s_cbranch_scc1 L_end
  s_sleep 1
  s_branch spin_34
done_35:
ldback_33:
  s_mov_b32 m0, s57
  s_sub_u32 s52, s63, 17
  s_ashr_i32 s61, s52, 2
  s_add_u32 s61, s61, 1
  s_and_b32 s52, s52, 3
  s_lshl_b32 s52, s52, 8
  s_add_u32 s52, s52, 147712
  v_mov_b32 v21, s52
  ds_read_b32 v22, v21
  s_waitcnt vmcnt(31)
  buffer_load_dwordx4 v4, s[32:35], s58 offen offset:0 nt lds
  s_waitcnt vmcnt(31)
  buffer_load_dwordx4 v5, s[32:35], s58 offen offset:1024 nt lds
  s_waitcnt vmcnt(31)
  buffer_load_dwordx4 v4, s[32:35], s58 offen offset:2048 nt lds
  s_waitcnt vmcnt(31)
  buffer_load_dwordx4 v5, s[32:35], s58 offen offset:3072 nt lds
  s_add_u32 m0, m0, 4096
  s_waitcnt vmcnt(31)
  buffer_load_dwordx4 v4, s[32:35], s59 offen offset:0 nt lds
  s_waitcnt vmcnt(31)
  buffer_load_dwordx4 v5, s[32:35], s59 offen offset:1024 nt lds
  s_waitcnt vmcnt(31)
  buffer_load_dwordx4 v4, s[32:35], s59 offen offset:2048 nt lds
  s_waitcnt vmcnt(31)
  buffer_load_dwordx4 v5, s[32:35], s59 offen offset:3072 nt lds
  v_mov_b32 v7, s60
  ds_write_b32 v6, v7
  s_or_b32 s58, s58, 0xff691c00
  s_add_u32 s58, s58, 1024
  s_and_b32 s58, s58, 0x96e000
  s_add_u32 s59, s58, 4096
  s_add_u32 s57, s57, 8192
  s_cmp_ge_u32 s57, 147456
  s_cselect_b32 s57, 0, s57
  s_add_u32 s60, s60, 1
  s_add_u32 s63, s63, 1
  s_cmp_lt_u32 s63, 256
  s_cbranch_scc1 ld_32
  v_mov_b32 v21, 147712
  s_cmp_lt_u32 s2, 72
  s_cbranch_scc1 wO_36
  s_cmp_ge_u32 s2, 112
  s_cbranch_scc1 wF_37
  s_mul_i32 s57, s54, 1152
  s_sub_u32 s61, 5308416, s57
  s_add_u32 s40, s16, s57
  s_addc_u32 s41, s17, 0
  s_mov_b32 s42, s61
  s_mov_b32 s43, 0x20000
  s_add_u32 s44, s18, s57
  s_addc_u32 s45, s19, 0
  s_mov_b32 s46, s61
  s_mov_b32 s47, 0x20000
  s_sub_u32 s59, s55, 9
  s_mul_i32 s59, s59, 64512
  v_mul_u32_u24 v8, 7282, v1
  v_lshrrev_b32 v8, 16, v8
  v_mul_u32_u24 v9, 9, v8
  v_sub_u32 v9, v1, v9
  v_mul_u32_u24 v8, 9216, v8
  v_lshl_add_u32 v15, v9, 7, v8
  v_lshlrev_b32 v18, 7, v1
  s_bfm_b64 exec, 63, 0
  s_mul_i32 s57, s54, 589824
  s_sub_u32 s53, 13, s55
  s_lshl_b32 s53, s53, 13
  s_mov_b64 exec, -1
  v_add_u32 v18, s53, v18
  s_bfm_b64 exec, 63, 0
  s_add_u32 s36, s12, s57
  s_addc_u32 s37, s13, 0
  s_mov_b32 s38, 589824
  s_mov_b32 s39, 0x20000
  s_mov_b64 s[98:99], exec
  s_mov_b64 exec, -1
  v_add_u32 v31, 548864, v18
  s_waitcnt vmcnt(27)
  buffer_load_dword v30, v31, s[36:39], 0 offen
  s_mov_b64 exec, s[98:99]
  s_waitcnt vmcnt(25)
  v_mov_b32 v7, 253
  ds_write_b32 v6, v7
  s_mov_b64 s[98:99], exec
  s_mov_b64 exec, -1
  v_add_u32 v31, 507904, v18
  s_waitcnt vmcnt(24)
  buffer_load_dword v30, v31, s[36:39], 0 offen
  s_mov_b64 exec, s[98:99]
  s_mov_b64 s[98:99], exec
  s_mov_b64 exec, -1
  v_add_u32 v31, 466944, v18
  s_waitcnt vmcnt(21)
  buffer_load_dword v30, v31, s[36:39], 0 offen
  s_mov_b64 exec, s[98:99]
  s_waitcnt vmcnt(19)
  v_mov_b32 v7, 254
  ds_write_b32 v6, v7
  s_mov_b64 s[98:99], exec
  s_mov_b64 exec, -1
  v_add_u32 v31, 425984, v18
  s_waitcnt vmcnt(18)
  buffer_load_dword v30, v31, s[36:39], 0 offen
  s_mov_b64 exec, s[98:99]
  s_mov_b64 s[98:99], exec
  s_mov_b64 exec, -1
  v_add_u32 v31, 385024, v18
  s_waitcnt vmcnt(15)
  buffer_load_dword v30, v31, s[36:39], 0 offen
  s_mov_b64 exec, s[98:99]
  s_waitcnt vmcnt(13)
  v_mov_b32 v7, 255
  ds_write_b32 v6, v7
  s_waitcnt vmcnt(5)
  v_mov_b32 v7, 256
  ds_write_b32 v6, v7
  v_mov_b32 v24, 148776
spin_38:
  ds_read_b32 v25, v24 offset:0
  s_waitcnt lgkmcnt(0)
  v_readfirstlane_b32 s52, v25
  s_nop 0
  s_cmp_ge_i32 s52, 1
  s_cbranch_scc1 done_39
  s_sub_u32 s62, s62, 1
  s_cbranch_scc1 L_end
  s_branch spin_38
done_39:
  s_mov_b64 s[98:99], exec
  s_mov_b64 exec, -1
  v_add_u32 v31, 344064, v18
  s_waitcnt vmcnt(12)
  buffer_load_dword v30, v31, s[36:39], 0 offen
  s_mov_b64 exec, s[98:99]
  s_mov_b64 s[98:99], exec
  s_mov_b64 exec, -1
  v_add_u32 v31, 303104, v18
  s_waitcnt vmcnt(9)
  buffer_load_dword v30, v31, s[36:39], 0 offen
  s_mov_b64 exec, s[98:99]
  s_sub_u32 s58, 5243904, s59
  s_waitcnt vmcnt(6)
  buffer_load_dword v30, v15, s[40:43], s58 offen
  s_sub_u32 s58, 5243904, s59
  s_waitcnt vmcnt(6)
  buffer_load_dword v30, v15, s[44:47], s58 offen
  s_sub_u32 s58, 2589696, s59
  s_waitcnt vmcnt(6)
  buffer_load_dword v30, v15, s[40:43], s58 offen
  s_sub_u32 s58, 2589696, s59
  s_waitcnt vmcnt(6)
  buffer_load_dword v30, v15, s[44:47], s58 offen
  s_sub_u32 s58, 4921344, s59
  s_waitcnt vmcnt(6)
  buffer_load_dword v30, v15, s[40:43], s58 offen
  s_sub_u32 s58, 4921344, s59
  s_waitcnt vmcnt(6)
  buffer_load_dword v30, v15, s[44:47], s58 offen
  s_sub_u32 s58, 2267136, s59
  s_waitcnt vmcnt(6)
  buffer_load_dword v30, v15, s[40:43], s58 offen
  s_sub_u32 s58, 2267136, s59
  s_waitcnt vmcnt(6)
  buffer_load_dword v30, v15, s[44:47], s58 offen
  s_sub_u32 s58, 4598784, s59
  s_waitcnt vmcnt(6)
  buffer_load_dword v30, v15, s[40:43], s58 offen
  s_sub_u32 s58, 4598784, s59
  s_waitcnt vmcnt(6)
  buffer_load_dword v30, v15, s[44:47], s58 offen
  s_sub_u32 s58, 1944576, s59
  s_waitcnt vmcnt(6)
  buffer_load_dword v30, v15, s[40:43], s58 offen
  s_sub_u32 s58, 1944576, s59
  s_waitcnt vmcnt(6)
  buffer_load_dword v30, v15, s[44:47], s58 offen
  s_sub_u32 s58, 4276224, s59
  s_waitcnt vmcnt(6)
  buffer_load_dword v30, v15, s[40:43], s58 offen
  s_sub_u32 s58, 4276224, s59
  s_waitcnt vmcnt(6)
  buffer_load_dword v30, v15, s[44:47], s58 offen
  s_sub_u32 s58, 1622016, s59
  s_waitcnt vmcnt(6)
  buffer_load_dword v30, v15, s[40:43], s58 offen
  s_sub_u32 s58, 1622016, s59
  s_waitcnt vmcnt(6)
  buffer_load_dword v30, v15, s[44:47], s58 offen
  s_waitcnt lgkmcnt(0)
  s_branch L_fin
wO_36:
fc_40:
  ds_read_b32 v24, v21
  ds_read_b32 v25, v21 offset:256
  ds_read_b32 v26, v21 offset:512
  ds_read_b32 v27, v21 offset:768
  s_waitcnt lgkmcnt(0)
  v_min_i32 v24, v24, v25
  v_min3_i32 v24, v24, v26, v27
  s_nop 0
  v_readfirstlane_b32 s52, v24
  s_nop 0
  s_cmp_ge_i32 s52, 60
  s_cbranch_scc1 fcd_41
  s_sub_u32 s62, s62, 1
  s_cbranch_scc1 L_end
  s_branch fc_40
fcd_41:
  s_mov_b32 m0, 32768
  s_mov_b32 s58, 0
  s_waitcnt vmcnt(31)
  buffer_load_dwordx4 v12, s[36:39], s58 offen  lds
  s_mov_b32 m0, 33792
  s_mov_b32 s58, 9216
  s_waitcnt vmcnt(31)
  buffer_load_dwordx4 v16, s[36:39], s58 offen  lds
  s_mov_b32 m0, 34816
  s_mov_b32 s58, 18432
  s_waitcnt vmcnt(31)
  buffer_load_dwordx4 v12, s[36:39], s58 offen  lds
  s_mov_b32 m0, 35840
  s_mov_b32 s58, 27648
  s_waitcnt vmcnt(31)
  buffer_load_dwordx4 v16, s[36:39], s58 offen  lds
  s_mov_b32 m0, 36864
  s_mov_b32 s58, 36864
  s_waitcnt vmcnt(31)
  buffer_load_dwordx4 v12, s[36:39], s58 offen  lds
  s_mov_b32 m0, 37888
  s_mov_b32 s58, 46080
  s_waitcnt vmcnt(31)
  buffer_load_dwordx4 v16, s[36:39], s58 offen  lds
  s_mov_b32 m0, 38912
  s_mov_b32 s58, 55296
  s_waitcnt vmcnt(31)
  buffer_load_dwordx4 v12, s[36:39], s58 offen  lds
  s_mov_b32 m0, 39936
  s_mov_b32 s58, 64512
  s_waitcnt vmcnt(31)
  buffer_load_dwordx4 v16, s[36:39], s58 offen  lds
  v_mov_b32 v7, 253
  ds_write_b32 v6, v7
  s_mov_b32 m0, 40960
  s_mov_b32 s58, 73728
  s_waitcnt vmcnt(31)
  buffer_load_dwordx4 v12, s[36:39], s58 offen  lds
  s_mov_b32 m0, 41984
  s_mov_b32 s58, 82944
  s_waitcnt vmcnt(31)
  buffer_load_dwordx4 v16, s[36:39], s58 offen  lds
  s_mov_b32 m0, 43008
  s_mov_b32 s58, 92160
  s_waitcnt vmcnt(31)
  buffer_load_dwordx4 v12, s[36:39], s58 offen  lds
  s_mov_b32 m0, 44032
  s_mov_b32 s58, 101376
  s_waitcnt vmcnt(31)
  buffer_load_dwordx4 v16, s[36:39], s58 offen  lds
  s_mov_b32 m0, 45056
  s_mov_b32 s58, 110592
  s_waitcnt vmcnt(31)
  buffer_load_dwordx4 v12, s[36:39], s58 offen  lds
  s_mov_b32 m0, 46080
  s_mov_b32 s58, 119808
  s_waitcnt vmcnt(31)
  buffer_load_dwordx4 v16, s[36:39], s58 offen  lds
  s_mov_b32 m0, 47104
  s_mov_b32 s58, 129024
  s_waitcnt vmcnt(31)
  buffer_load_dwordx4 v12, s[36:39], s58 offen  lds
  s_mov_b32 m0, 48128
  s_mov_b32 s58, 138240
  s_waitcnt vmcnt(31)
  buffer_load_dwordx4 v16, s[36:39], s58 offen  lds
  v_mov_b32 v7, 254
  ds_write_b32 v6, v7
fc_42:
  ds_read_b32 v24, v21
  ds_read_b32 v25, v21 offset:256
  ds_read_b32 v26, v21 offset:512
  ds_read_b32 v27, v21 offset:768
  s_waitcnt lgkmcnt(0)
  v_min_i32 v24, v24, v25
  v_min3_i32 v24, v24, v26, v27
  s_nop 0
  v_readfirstlane_b32 s52, v24
  s_nop 0
  s_cmp_ge_i32 s52, 61
  s_cbranch_scc1 fcd_43
  s_sub_u32 s62, s62, 1
  s_cbranch_scc1 L_end
  s_branch fc_42
fcd_43:
  s_mov_b32 m0, 49152
  s_mov_b32 s58, 147456
  s_waitcnt vmcnt(31)
  buffer_load_dwordx4 v12, s[36:39], s58 offen  lds
  s_mov_b32 m0, 50176
  s_mov_b32 s58, 156672
  s_waitcnt vmcnt(31)
  buffer_load_dwordx4 v16, s[36:39], s58 offen  lds
  s_mov_b32 m0, 51200
  s_mov_b32 s58, 165888
  s_waitcnt vmcnt(31)
  buffer_load_dwordx4 v12, s[36:39], s58 offen  lds
  s_mov_b32 m0, 52224
  s_mov_b32 s58, 175104
  s_waitcnt vmcnt(31)
  buffer_load_dwordx4 v16, s[36:39], s58 offen  lds
  s_mov_b32 m0, 53248
  s_mov_b32 s58, 184320
  s_waitcnt vmcnt(31)
  buffer_load_dwordx4 v12, s[36:39], s58 offen  lds
  s_mov_b32 m0, 54272
  s_mov_b32 s58, 193536
  s_waitcnt vmcnt(31)
  buffer_load_dwordx4 v16, s[36:39], s58 offen  lds
  s_mov_b32 m0, 55296
  s_mov_b32 s58, 202752
  s_waitcnt vmcnt(31)
  buffer_load_dwordx4 v12, s[36:39], s58 offen  lds
  s_mov_b32 m0, 56320
  s_mov_b32 s58, 211968
  s_waitcnt vmcnt(31)
  buffer_load_dwordx4 v16, s[36:39], s58 offen  lds
  v_mov_b32 v7, 255
  ds_write_b32 v6, v7
  s_mov_b32 m0, 57344
  s_mov_b32 s58, 221184
  s_waitcnt vmcnt(31)
  buffer_load_dwordx4 v12, s[36:39], s58 offen  lds
  s_mov_b32 m0, 58368
  s_mov_b32 s58, 230400
  s_waitcnt vmcnt(31)
  buffer_load_dwordx4 v16, s[36:39], s58 offen  lds
  s_mov_b32 m0, 59392
  s_mov_b32 s58, 239616
  s_waitcnt vmcnt(31)
  buffer_load_dwordx4 v12, s[36:39], s58 offen  lds
  s_mov_b32 m0, 60416
  s_mov_b32 s58, 248832
  s_waitcnt vmcnt(31)
  buffer_load_dwordx4 v16, s[36:39], s58 offen  lds
  s_mov_b32 m0, 61440
  s_mov_b32 s58, 258048
  s_waitcnt vmcnt(31)
  buffer_load_dwordx4 v12, s[36:39], s58 offen  lds
  s_mov_b32 m0, 62464
  s_mov_b32 s58, 267264
  s_waitcnt vmcnt(31)
  buffer_load_dwordx4 v16, s[36:39], s58 offen  lds
  s_mov_b32 m0, 63488
  s_mov_b32 s58, 276480
  s_waitcnt vmcnt(31)
  buffer_load_dwordx4 v12, s[36:39], s58 offen  lds
  s_mov_b32 m0, 64512
  s_mov_b32 s58, 285696
  s_waitcnt vmcnt(35)
  buffer_load_dwordx4 v16, s[36:39], s58 offen  lds
  s_mov_b32 m0, 65536
  s_mov_b32 s58, 294912
  s_waitcnt vmcnt(35)
  buffer_load_dwordx4 v12, s[36:39], s58 offen  lds
  s_mov_b32 m0, 66560
  s_mov_b32 s58, 304128
  s_waitcnt vmcnt(35)
  buffer_load_dwordx4 v16, s[36:39], s58 offen  lds
  s_mov_b32 m0, 67584
  s_mov_b32 s58, 313344
  s_waitcnt vmcnt(35)
  buffer_load_dwordx4 v12, s[36:39], s58 offen  lds
  s_mov_b32 m0, 68608
  s_mov_b32 s58, 322560
  s_waitcnt vmcnt(35)
  buffer_load_dwordx4 v16, s[36:39], s58 offen  lds
  v_mov_b32 v7, 256
  ds_write_b32 v6, v7
  s_mov_b32 m0, 69632
  s_mov_b32 s58, 331776
  s_waitcnt vmcnt(35)
  buffer_load_dwordx4 v12, s[36:39], s58 offen  lds
  s_mov_b32 m0, 70656
  s_mov_b32 s58, 340992
  s_waitcnt vmcnt(35)
  buffer_load_dwordx4 v16, s[36:39], s58 offen  lds
  s_mov_b32 m0, 71680
  s_mov_b32 s58, 350208
  s_waitcnt vmcnt(35)
  buffer_load_dwordx4 v12, s[36:39], s58 offen  lds
  s_mov_b32 m0, 72704
  s_mov_b32 s58, 359424
  s_waitcnt vmcnt(35)
  buffer_load_dwordx4 v16, s[36:39], s58 offen  lds
  s_mov_b32 m0, 73728
  s_mov_b32 s58, 368640
  s_waitcnt vmcnt(35)
  buffer_load_dwordx4 v12, s[36:39], s58 offen  lds
  s_mov_b32 m0, 74752
  s_mov_b32 s58, 377856
  s_waitcnt vmcnt(35)
  buffer_load_dwordx4 v16, s[36:39], s58 offen  lds
  s_mov_b32 m0, 75776
  s_mov_b32 s58, 387072
  s_waitcnt vmcnt(35)
  buffer_load_dwordx4 v12, s[36:39], s58 offen  lds
  s_mov_b32 m0, 76800
  s_mov_b32 s58, 396288
  s_waitcnt vmcnt(35)
  buffer_load_dwordx4 v16, s[36:39], s58 offen  lds
  s_mov_b32 m0, 77824
  s_mov_b32 s58, 405504
  s_waitcnt vmcnt(35)
  buffer_load_dwordx4 v12, s[36:39], s58 offen  lds
  s_mov_b32 m0, 78848
  s_mov_b32 s58, 414720
  s_waitcnt vmcnt(35)
  buffer_load_dwordx4 v16, s[36:39], s58 offen  lds
  s_mov_b32 m0, 79872
  s_mov_b32 s58, 423936
  s_waitcnt vmcnt(35)
  buffer_load_dwordx4 v12, s[36:39], s58 offen  lds
  s_mov_b32 m0, 80896
  s_mov_b32 s58, 433152
  s_waitcnt vmcnt(35)
  buffer_load_dwordx4 v16, s[36:39], s58 offen  lds
fc_44:
  ds_read_b32 v24, v21
  ds_read_b32 v25, v21 offset:256
  ds_read_b32 v26, v21 offset:512
  ds_read_b32 v27, v21 offset:768
  s_waitcnt lgkmcnt(0)
  v_min_i32 v24, v24, v25
  v_min3_i32 v24, v24, v26, v27
  s_nop 0
  v_readfirstlane_b32 s52, v24
  s_nop 0
  s_cmp_ge_i32 s52, 62
  s_cbranch_scc1 fcd_45
  s_sub_u32 s62, s62, 1
  s_cbranch_scc1 L_end
  s_branch fc_44
fcd_45:
  s_mov_b32 m0, 81920
  s_mov_b32 s58, 442368
  s_waitcnt vmcnt(35)
  buffer_load_dwordx4 v12, s[36:39], s58 offen  lds
  s_mov_b32 m0, 82944
  s_mov_b32 s58, 451584
  s_waitcnt vmcnt(35)
  buffer_load_dwordx4 v16, s[36:39], s58 offen  lds
  s_mov_b32 m0, 83968
  s_mov_b32 s58, 460800
  s_waitcnt vmcnt(35)
  buffer_load_dwordx4 v12, s[36:39], s58 offen  lds
  s_mov_b32 m0, 84992
  s_mov_b32 s58, 470016
  s_waitcnt vmcnt(35)
  buffer_load_dwordx4 v16, s[36:39], s58 offen  lds
  s_mov_b32 m0, 86016
  s_mov_b32 s58, 479232
  s_waitcnt vmcnt(35)
  buffer_load_dwordx4 v12, s[36:39], s58 offen  lds
  s_mov_b32 m0, 87040
  s_mov_b32 s58, 488448
  s_waitcnt vmcnt(35)
  buffer_load_dwordx4 v16, s[36:39], s58 offen  lds
  s_mov_b32 m0, 88064
  s_mov_b32 s58, 497664
  s_waitcnt vmcnt(35)
  buffer_load_dwordx4 v12, s[36:39], s58 offen  lds
  s_mov_b32 m0, 89088
  s_mov_b32 s58, 506880
  s_waitcnt vmcnt(35)
  buffer_load_dwordx4 v16, s[36:39], s58 offen  lds
  s_mov_b32 m0, 90112
  s_mov_b32 s58, 516096
  s_waitcnt vmcnt(35)
  buffer_load_dwordx4 v12, s[36:39], s58 offen  lds
  s_mov_b32 m0, 91136
  s_mov_b32 s58, 525312
  s_waitcnt vmcnt(35)
  buffer_load_dwordx4 v16, s[36:39], s58 offen  lds
  s_mov_b32 m0, 92160
  s_mov_b32 s58, 534528
  s_waitcnt vmcnt(35)
  buffer_load_dwordx4 v12, s[36:39], s58 offen  lds
  s_mov_b32 m0, 93184
  s_mov_b32 s58, 543744
  s_waitcnt vmcnt(35)
  buffer_load_dwordx4 v16, s[36:39], s58 offen  lds
  s_mov_b32 m0, 94208
  s_mov_b32 s58, 552960
  s_waitcnt vmcnt(35)
  buffer_load_dwordx4 v12, s[36:39], s58 offen  lds
  s_mov_b32 m0, 95232
  s_mov_b32 s58, 562176
  s_waitcnt vmcnt(35)
  buffer_load_dwordx4 v16, s[36:39], s58 offen  lds
  s_mov_b32 m0, 96256
  s_mov_b32 s58, 571392
  s_waitcnt vmcnt(35)
  buffer_load_dwordx4 v12, s[36:39], s58 offen  lds
  s_mov_b32 m0, 97280
  s_mov_b32 s58, 580608
  s_waitcnt vmcnt(35)
  buffer_load_dwordx4 v16, s[36:39], s58 offen  lds
  s_waitcnt vmcnt(20)
  v_mov_b32 v24, 148780
  v_mov_b32 v25, 1
  s_mov_b64 exec, 1
  ds_write_b32 v24, v25
  s_mov_b64 exec, -1
  s_waitcnt vmcnt(0)
  v_mov_b32 v7, 257
  ds_write_b32 v6, v7
  s_waitcnt lgkmcnt(0)
  s_branch L_fin
wF_37:
fc_46:
  ds_read_b32 v24, v21
  ds_read_b32 v25, v21 offset:256
  ds_read_b32 v26, v21 offset:512
  ds_read_b32 v27, v21 offset:768
  s_waitcnt lgkmcnt(0)
  v_min_i32 v24, v24, v25
  v_min3_i32 v24, v24, v26, v27
  s_nop 0
  v_readfirstlane_b32 s52, v24
  s_nop 0
  s_cmp_ge_i32 s52, 62
  s_cbranch_scc1 fcd_47
  s_sub_u32 s62, s62, 1
  s_cbranch_scc1 L_end
  s_branch fc_46
fcd_47:
  s_waitcnt vmcnt(24)
  v_mov_b32 v7, 253
  ds_write_b32 v6, v7
  s_waitcnt vmcnt(16)
  v_mov_b32 v7, 254
  ds_write_b32 v6, v7
  s_waitcnt vmcnt(8)
  v_mov_b32 v7, 255
  ds_write_b32 v6, v7
  s_lshl_b32 s99, s97, 10
  s_add_u32 m0, s99, 32768
  s_mul_i32 s58, s97, 147456
  s_waitcnt vmcnt(6)
  buffer_load_dwordx4 v13, s[40:43], s58 offen  lds
  s_add_u32 m0, s99, 69632
  s_add_u32 s97, s97, 1
  s_cmp_eq_u32 s97, 36
  s_cselect_b32 s97, 0, s97
  s_waitcnt vmcnt(6)
  buffer_load_dwordx4 v17, s[44:47], s58 offen  lds
  s_lshl_b32 s99, s97, 10
  s_add_u32 m0, s99, 32768
  s_mul_i32 s58, s97, 147456
  s_waitcnt vmcnt(6)
  buffer_load_dwordx4 v13, s[40:43], s58 offen  lds
  s_add_u32 m0, s99, 69632
  s_add_u32 s97, s97, 1
  s_cmp_eq_u32 s97, 36
  s_cselect_b32 s97, 0, s97
  s_waitcnt vmcnt(6)
  buffer_load_dwordx4 v17, s[44:47], s58 offen  lds
  s_lshl_b32 s99, s97, 10
  s_add_u32 m0, s99, 32768
  s_mul_i32 s58, s97, 147456
  s_waitcnt vmcnt(6)
  buffer_load_dwordx4 v13, s[40:43], s58 offen  lds
  s_add_u32 m0, s99, 69632
  s_add_u32 s97, s97, 1
  s_cmp_eq_u32 s97, 36
  s_cselect_b32 s97, 0, s97
  s_waitcnt vmcnt(6)
  buffer_load_dwordx4 v17, s[44:47], s58 offen  lds
  s_lshl_b32 s99, s97, 10
  s_add_u32 m0, s99, 32768
  s_mul_i32 s58, s97, 147456
  s_waitcnt vmcnt(6)
  buffer_load_dwordx4 v13, s[40:43], s58 offen  lds
  v_mov_b32 v7, 256
  ds_write_b32 v6, v7
  s_add_u32 m0, s99, 69632
  s_add_u32 s97, s97, 1
  s_cmp_eq_u32 s97, 36
  s_cselect_b32 s97, 0, s97
  s_waitcnt vmcnt(6)
  buffer_load_dwordx4 v17, s[44:47], s58 offen  lds
  s_lshl_b32 s99, s97, 10
  s_add_u32 m0, s99, 32768
  s_mul_i32 s58, s97, 147456
  s_waitcnt vmcnt(6)
  buffer_load_dwordx4 v13, s[40:43], s58 offen  lds
  s_add_u32 m0, s99, 69632
  s_add_u32 s97, s97, 1
  s_cmp_eq_u32 s97, 36
  s_cselect_b32 s97, 0, s97
  s_waitcnt vmcnt(6)
  buffer_load_dwordx4 v17, s[44:47], s58 offen  lds
  s_lshl_b32 s99, s97, 10
  s_add_u32 m0, s99, 32768
  s_mul_i32 s58, s97, 147456
  s_waitcnt vmcnt(6)
  buffer_load_dwordx4 v13, s[40:43], s58 offen  lds
  s_add_u32 m0, s99, 69632
  s_add_u32 s97, s97, 1
  s_cmp_eq_u32 s97, 36
  s_cselect_b32 s97, 0, s97
  s_waitcnt vmcnt(6)
  buffer_load_dwordx4 v17, s[44:47], s58 offen  lds
  s_lshl_b32 s99, s97, 10
  s_add_u32 m0, s99, 32768
  s_mul_i32 s58, s97, 147456
  s_waitcnt vmcnt(13)
  buffer_load_dwordx4 v13, s[40:43], s58 offen  lds
  s_add_u32 m0, s99, 69632
  s_add_u32 s97, s97, 1
  s_cmp_eq_u32 s97, 36
  s_cselect_b32 s97, 0, s97
  s_waitcnt vmcnt(13)
  buffer_load_dwordx4 v17, s[44:47], s58 offen  lds
  s_lshl_b32 s99, s97, 10
  s_add_u32 m0, s99, 32768
  s_mul_i32 s58, s97, 147456
  s_waitcnt vmcnt(13)
  buffer_load_dwordx4 v13, s[40:43], s58 offen  lds
  s_add_u32 m0, s99, 69632
  s_add_u32 s97, s97, 1
  s_cmp_eq_u32 s97, 36
  s_cselect_b32 s97, 0, s97
  s_waitcnt vmcnt(13)
  buffer_load_dwordx4 v17, s[44:47], s58 offen  lds
  s_lshl_b32 s99, s97, 10
  s_add_u32 m0, s99, 32768
  s_mul_i32 s58, s97, 147456
  s_waitcnt vmcnt(13)
  buffer_load_dwordx4 v13, s[40:43], s58 offen  lds
  s_add_u32 m0, s99, 69632
  s_add_u32 s97, s97, 1
  s_cmp_eq_u32 s97, 36
  s_cselect_b32 s97, 0, s97
  s_waitcnt vmcnt(13)
  buffer_load_dwordx4 v17, s[44:47], s58 offen  lds
  s_lshl_b32 s99, s97, 10
  s_add_u32 m0, s99, 32768
  s_mul_i32 s58, s97, 147456
  s_waitcnt vmcnt(13)
  buffer_load_dwordx4 v13, s[40:43], s58 offen  lds
  s_add_u32 m0, s99, 69632
  s_add_u32 s97, s97, 1
  s_cmp_eq_u32 s97, 36
  s_cselect_b32 s97, 0, s97
  s_waitcnt vmcnt(13)
  buffer_load_dwordx4 v17, s[44:47], s58 offen  lds
  s_lshl_b32 s99, s97, 10
  s_add_u32 m0, s99, 32768
  s_mul_i32 s58, s97, 147456
  s_waitcnt vmcnt(13)
  buffer_load_dwordx4 v13, s[40:43], s58 offen  lds
  s_add_u32 m0, s99, 69632
  s_add_u32 s97, s97, 1
  s_cmp_eq_u32 s97, 36
  s_cselect_b32 s97, 0, s97
  s_waitcnt vmcnt(13)
  buffer_load_dwordx4 v17, s[44:47], s58 offen  lds
  s_lshl_b32 s99, s97, 10
  s_add_u32 m0, s99, 32768
  s_mul_i32 s58, s97, 147456
  s_waitcnt vmcnt(13)
  buffer_load_dwordx4 v13, s[40:43], s58 offen  lds
  s_add_u32 m0, s99, 69632
  s_add_u32 s97, s97, 1
  s_cmp_eq_u32 s97, 36
  s_cselect_b32 s97, 0, s97
  s_waitcnt vmcnt(13)
  buffer_load_dwordx4 v17, s[44:47], s58 offen  lds
  s_lshl_b32 s99, s97, 10
  s_add_u32 m0, s99, 32768
  s_mul_i32 s58, s97, 147456
  s_waitcnt vmcnt(13)
  buffer_load_dwordx4 v13, s[40:43], s58 offen  lds
  s_add_u32 m0, s99, 69632
  s_add_u32 s97, s97, 1
  s_cmp_eq_u32 s97, 36
  s_cselect_b32 s97, 0, s97
  s_waitcnt vmcnt(13)
  buffer_load_dwordx4 v17, s[44:47], s58 offen  lds
  s_lshl_b32 s99, s97, 10
  s_add_u32 m0, s99, 32768
  s_mul_i32 s58, s97, 147456
  s_waitcnt vmcnt(27)
  buffer_load_dwordx4 v13, s[40:43], s58 offen  lds
  s_add_u32 m0, s99, 69632
  s_add_u32 s97, s97, 1
  s_cmp_eq_u32 s97, 36
  s_cselect_b32 s97, 0, s97
  s_waitcnt vmcnt(27)
  buffer_load_dwordx4 v17, s[44:47], s58 offen  lds
  s_lshl_b32 s99, s97, 10
  s_add_u32 m0, s99, 32768
  s_mul_i32 s58, s97, 147456
  s_waitcnt vmcnt(27)
  buffer_load_dwordx4 v13, s[40:43], s58 offen  lds
  s_add_u32 m0, s99, 69632
  s_add_u32 s97, s97, 1
  s_cmp_eq_u32 s97, 36
  s_cselect_b32 s97, 0, s97
  s_waitcnt vmcnt(27)
  buffer_load_dwordx4 v17, s[44:47], s58 offen  lds
  s_lshl_b32 s99, s97, 10
  s_add_u32 m0, s99, 32768
  s_mul_i32 s58, s97, 147456
  s_waitcnt vmcnt(27)
  buffer_load_dwordx4 v13, s[40:43], s58 offen  lds
  s_add_u32 m0, s99, 69632
  s_add_u32 s97, s97, 1
  s_cmp_eq_u32 s97, 36
  s_cselect_b32 s97, 0, s97
  s_waitcnt vmcnt(27)
  buffer_load_dwordx4 v17, s[44:47], s58 offen  lds
  s_lshl_b32 s99, s97, 10
  s_add_u32 m0, s99, 32768
  s_mul_i32 s58, s97, 147456
  s_waitcnt vmcnt(27)
  buffer_load_dwordx4 v13, s[40:43], s58 offen  lds
  s_add_u32 m0, s99, 69632
  s_add_u32 s97, s97, 1
  s_cmp_eq_u32 s97, 36
  s_cselect_b32 s97, 0, s97
  s_waitcnt vmcnt(27)
  buffer_load_dwordx4 v17, s[44:47], s58 offen  lds
  s_lshl_b32 s99, s97, 10
  s_add_u32 m0, s99, 32768
  s_mul_i32 s58, s97, 147456
  s_waitcnt vmcnt(27)
  buffer_load_dwordx4 v13, s[40:43], s58 offen  lds
  s_add_u32 m0, s99, 69632
  s_add_u32 s97, s97, 1
  s_cmp_eq_u32 s97, 36
  s_cselect_b32 s97, 0, s97
  s_waitcnt vmcnt(27)
  buffer_load_dwordx4 v17, s[44:47], s58 offen  lds
  s_lshl_b32 s99, s97, 10
  s_add_u32 m0, s99, 32768
  s_mul_i32 s58, s97, 147456
  s_waitcnt vmcnt(27)
  buffer_load_dwordx4 v13, s[40:43], s58 offen  lds
  s_add_u32 m0, s99, 69632
  s_add_u32 s97, s97, 1
  s_cmp_eq_u32 s97, 36
  s_cselect_b32 s97, 0, s97
  s_waitcnt vmcnt(27)
  buffer_load_dwordx4 v17, s[44:47], s58 offen  lds
  s_lshl_b32 s99, s97, 10
  s_add_u32 m0, s99, 32768
  s_mul_i32 s58, s97, 147456
  s_waitcnt vmcnt(27)
  buffer_load_dwordx4 v13, s[40:43], s58 offen  lds
  s_add_u32 m0, s99, 69632
  s_add_u32 s97, s97, 1
  s_cmp_eq_u32 s97, 36
  s_cselect_b32 s97, 0, s97
  s_waitcnt vmcnt(27)
  buffer_load_dwordx4 v17, s[44:47], s58 offen  lds
  s_lshl_b32 s99, s97, 10
  s_add_u32 m0, s99, 32768
  s_mul_i32 s58, s97, 147456
  s_waitcnt vmcnt(27)
  buffer_load_dwordx4 v13, s[40:43], s58 offen  lds
  s_add_u32 m0, s99, 69632
  s_add_u32 s97, s97, 1
  s_cmp_eq_u32 s97, 36
  s_cselect_b32 s97, 0, s97
  s_waitcnt vmcnt(27)
  buffer_load_dwordx4 v17, s[44:47], s58 offen  lds
  s_lshl_b32 s99, s97, 10
  s_add_u32 m0, s99, 32768
  s_mul_i32 s58, s97, 147456
  s_waitcnt vmcnt(27)
  buffer_load_dwordx4 v13, s[40:43], s58 offen  lds
  s_add_u32 m0, s99, 69632
  s_add_u32 s97, s97, 1
  s_cmp_eq_u32 s97, 36
  s_cselect_b32 s97, 0, s97
  s_waitcnt vmcnt(27)
  buffer_load_dwordx4 v17, s[44:47], s58 offen  lds
  s_lshl_b32 s99, s97, 10
  s_add_u32 m0, s99, 32768
  s_mul_i32 s58, s97, 147456
  s_waitcnt vmcnt(55)
  buffer_load_dwordx4 v13, s[40:43], s58 offen  lds
  s_add_u32 m0, s99, 69632
  s_add_u32 s97, s97, 1
  s_cmp_eq_u32 s97, 36
  s_cselect_b32 s97, 0, s97
  s_waitcnt vmcnt(55)
  buffer_load_dwordx4 v17, s[44:47], s58 offen  lds
  s_lshl_b32 s99, s97, 10
  s_add_u32 m0, s99, 32768
  s_mul_i32 s58, s97, 147456
  s_waitcnt vmcnt(55)
  buffer_load_dwordx4 v13, s[40:43], s58 offen  lds
  s_add_u32 m0, s99, 69632
  s_add_u32 s97, s97, 1
  s_cmp_eq_u32 s97, 36
  s_cselect_b32 s97, 0, s97
  s_waitcnt vmcnt(55)
  buffer_load_dwordx4 v17, s[44:47], s58 offen  lds
  s_lshl_b32 s99, s97, 10
  s_add_u32 m0, s99, 32768
  s_mul_i32 s58, s97, 147456
  s_waitcnt vmcnt(55)
  buffer_load_dwordx4 v13, s[40:43], s58 offen  lds
  s_add_u32 m0, s99, 69632
  s_add_u32 s97, s97, 1
  s_cmp_eq_u32 s97, 36
  s_cselect_b32 s97, 0, s97
  s_waitcnt vmcnt(55)
  buffer_load_dwordx4 v17, s[44:47], s58 offen  lds
  s_lshl_b32 s99, s97, 10
  s_add_u32 m0, s99, 32768
  s_mul_i32 s58, s97, 147456
  s_waitcnt vmcnt(55)
  buffer_load_dwordx4 v13, s[40:43], s58 offen  lds
  s_add_u32 m0, s99, 69632
  s_add_u32 s97, s97, 1
  s_cmp_eq_u32 s97, 36
  s_cselect_b32 s97, 0, s97
  s_waitcnt vmcnt(55)
  buffer_load_dwordx4 v17, s[44:47], s58 offen  lds
  s_lshl_b32 s99, s97, 10
  s_add_u32 m0, s99, 32768
  s_mul_i32 s58, s97, 147456
  s_waitcnt vmcnt(55)
  buffer_load_dwordx4 v13, s[40:43], s58 offen  lds
  s_add_u32 m0, s99, 69632
  s_add_u32 s97, s97, 1
  s_cmp_eq_u32 s97, 36
  s_cselect_b32 s97, 0, s97
  s_waitcnt vmcnt(55)
  buffer_load_dwordx4 v17, s[44:47], s58 offen  lds
  s_lshl_b32 s99, s97, 10
  s_add_u32 m0, s99, 32768
  s_mul_i32 s58, s97, 147456
  s_waitcnt vmcnt(55)
  buffer_load_dwordx4 v13, s[40:43], s58 offen  lds
  s_add_u32 m0, s99, 69632
  s_add_u32 s97, s97, 1
  s_cmp_eq_u32 s97, 36
  s_cselect_b32 s97, 0, s97
  s_waitcnt vmcnt(55)
  buffer_load_dwordx4 v17, s[44:47], s58 offen  lds
  s_lshl_b32 s99, s97, 10
  s_add_u32 m0, s99, 32768
  s_mul_i32 s58, s97, 147456
  s_waitcnt vmcnt(55)
  buffer_load_dwordx4 v13, s[40:43], s58 offen  lds
  s_add_u32 m0, s99, 69632
  s_add_u32 s97, s97, 1
  s_cmp_eq_u32 s97, 36
  s_cselect_b32 s97, 0, s97
  s_waitcnt vmcnt(55)
  buffer_load_dwordx4 v17, s[44:47], s58 offen  lds
  s_lshl_b32 s99, s97, 10
  s_add_u32 m0, s99, 32768
  s_mul_i32 s58, s97, 147456
  s_waitcnt vmcnt(55)
  buffer_load_dwordx4 v13, s[40:43], s58 offen  lds
  s_add_u32 m0, s99, 69632
  s_add_u32 s97, s97, 1
  s_cmp_eq_u32 s97, 36
  s_cselect_b32 s97, 0, s97
  s_waitcnt vmcnt(55)
  buffer_load_dwordx4 v17, s[44:47], s58 offen  lds
  s_lshl_b32 s99, s97, 10
  s_add_u32 m0, s99, 32768
  s_mul_i32 s58, s97, 147456
  s_waitcnt vmcnt(55)
  buffer_load_dwordx4 v13, s[40:43], s58 offen  lds
  s_add_u32 m0, s99, 69632
  s_add_u32 s97, s97, 1
  s_cmp_eq_u32 s97, 36
  s_cselect_b32 s97, 0, s97
  s_waitcnt vmcnt(55)
  buffer_load_dwordx4 v17, s[44:47], s58 offen  lds
  s_lshl_b32 s99, s97, 10
  s_add_u32 m0, s99, 32768
  s_mul_i32 s58, s97, 147456
  s_waitcnt vmcnt(55)
  buffer_load_dwordx4 v13, s[40:43], s58 offen  lds
  s_add_u32 m0, s99, 69632
  s_add_u32 s97, s97, 1
  s_cmp_eq_u32 s97, 36
  s_cselect_b32 s97, 0, s97
  s_waitcnt vmcnt(55)
  buffer_load_dwordx4 v17, s[44:47], s58 offen  lds
  s_lshl_b32 s99, s97, 10
  s_add_u32 m0, s99, 32768
  s_mul_i32 s58, s97, 147456
  s_waitcnt vmcnt(55)
  buffer_load_dwordx4 v13, s[40:43], s58 offen  lds
  s_add_u32 m0, s99, 69632
  s_add_u32 s97, s97, 1
  s_cmp_eq_u32 s97, 36
  s_cselect_b32 s97, 0, s97
  s_waitcnt vmcnt(55)
  buffer_load_dwordx4 v17, s[44:47], s58 offen  lds
  s_lshl_b32 s99, s97, 10
  s_add_u32 m0, s99, 32768
  s_mul_i32 s58, s97, 147456
  s_waitcnt vmcnt(55)
  buffer_load_dwordx4 v13, s[40:43], s58 offen  lds
  s_add_u32 m0, s99, 69632
  s_add_u32 s97, s97, 1
  s_cmp_eq_u32 s97, 36
  s_cselect_b32 s97, 0, s97
  s_waitcnt vmcnt(55)
  buffer_load_dwordx4 v17, s[44:47], s58 offen  lds
  s_lshl_b32 s99, s97, 10
  s_add_u32 m0, s99, 32768
  s_mul_i32 s58, s97, 147456
  s_waitcnt vmcnt(55)
  buffer_load_dwordx4 v13, s[40:43], s58 offen  lds
  s_add_u32 m0, s99, 69632
  s_add_u32 s97, s97, 1
  s_cmp_eq_u32 s97, 36
  s_cselect_b32 s97, 0, s97
  s_waitcnt vmcnt(55)
  buffer_load_dwordx4 v17, s[44:47], s58 offen  lds
  s_lshl_b32 s99, s97, 10
  s_add_u32 m0, s99, 32768
  s_mul_i32 s58, s97, 147456
  s_waitcnt vmcnt(55)
  buffer_load_dwordx4 v13, s[40:43], s58 offen  lds
  s_add_u32 m0, s99, 69632
  s_add_u32 s97, s97, 1
  s_cmp_eq_u32 s97, 36
  s_cselect_b32 s97, 0, s97
  s_waitcnt vmcnt(55)
  buffer_load_dwordx4 v17, s[44:47], s58 offen  lds
  s_waitcnt vmcnt(20)
  v_mov_b32 v24, 148780
  v_mov_b32 v25, 1
  s_mov_b64 exec, 1
  ds_write_b32 v24, v25
  s_mov_b64 exec, -1
  s_waitcnt vmcnt(0)
  v_mov_b32 v7, 258
  ds_write_b32 v6, v7
  s_waitcnt lgkmcnt(0)
  s_branch L_fin
L_cons:
  s_sub_u32 s3, s3, 1
  s_lshr_b32 s57, s1, 4
  v_lshlrev_b32 v4, 4, v1
  v_lshlrev_b32 v5, 1, v1
  v_lshlrev_b32 v6, 13, v2
  v_lshl_add_u32 v6, v3, 3, v6
  s_and_b32 s52, s1, 3
  s_mul_i32 s58, s52, 144
  s_mul_i32 s53, s3, 36
  s_add_u32 s58, s58, s53
  s_lshl_b32 s52, s58, 13
  s_lshr_b32 s53, s1, 2
  s_lshl_b32 s53, s53, 7
  s_add_u32 s59, s52, s53
  s_sub_u32 s60, 4718592, s59
  v_mov_b32 v7, 0
  s_waitcnt lgkmcnt(0)
  s_mov_b32 s32, s4
  s_mov_b32 s33, s5
  s_mov_b32 s34, 1152
  s_mov_b32 s35, 0x20000
  s_add_u32 s36, s10, s59
  s_addc_u32 s37, s11, 0
  s_mov_b32 s38, s60
  s_mov_b32 s39, 0x20000
  buffer_load_dwordx4 v[124:127], v4, s[32:35], 0 offen
  buffer_load_ushort v128, v5, s[32:35], 0 offen offset:1024
  s_mov_b32 s52, 0
  buffer_load_dwordx2 v[106:107], v6, s[36:39], s52 offen nt
  s_add_u32 s52, s52, 32768
  buffer_load_dwordx2 v[108:109], v6, s[36:39], s52 offen nt
  s_add_u32 s52, s52, 32768
  buffer_load_dwordx2 v[110:111], v6, s[36:39], s52 offen nt
  s_add_u32 s52, s52, 32768
  buffer_load_dwordx2 v[112:113], v6, s[36:39], s52 offen nt
  s_add_u32 s52, s52, 32768
  buffer_load_dwordx2 v[114:115], v6, s[36:39], s52 offen nt
  s_add_u32 s52, s52, 32768
  buffer_load_dwordx2 v[116:117], v6, s[36:39], s52 offen nt
  s_add_u32 s52, s52, 32768
  buffer_load_dwordx2 v[118:119], v6, s[36:39], s52 offen nt
  s_add_u32 s52, s52, 32768
  buffer_load_dwordx2 v[120:121], v6, s[36:39], s52 offen nt
  s_add_u32 s52, s52, 32768
  buffer_load_dwordx2 v[122:123], v6, s[36:39], s52 offen nt
  s_mov_b32 s28, s26
  s_mov_b32 s29, s27
  s_mov_b32 s30, 0x140000
  s_mov_b32 s31, 0x20000
  buffer_load_dword v16, v7, s[28:31], 0 offen offset:0 sc0 sc1
  s_and_b32 s54, s2, 7
  s_lshr_b32 s55, s2, 3
  s_mul_i32 s56, s54, 18
  s_add_u32 s56, s56, s55
  s_sub_u32 s56, s56, 14
  v_mov_b32 v12, -1
  v_mov_b32 v13, -1
  v_mov_b32 v14, -1
  v_mov_b32 v15, -1
  s_lshl_b32 s53, s3, 10
  v_add_u32 v9, s53, v4
  s_mul_i32 s52, s2, 2944
  s_add_u32 s52, s52, 327680
  v_cmp_gt_u32 vcc, 2944, v9
  v_add_u32 v9, s52, v9
  v_mov_b32 v8, 2147483632
  v_cndmask_b32 v9, v8, v9, vcc
  buffer_store_dwordx4 v[12:15], v9, s[28:31], 0 offen sc0 sc1
  v_lshlrev_b32 v21, 2, v1
  v_add_u32 v21, 147456, v21
  s_cmp_lg_u32 s3, 0
  s_cbranch_scc1 nz_48
  ds_write_b32 v21, v7 offset:0
  ds_write_b32 v21, v7 offset:256
  ds_write_b32 v21, v7 offset:512
  ds_write_b32 v21, v7 offset:768
  ds_write_b32 v21, v7 offset:1024
  ds_write_b32 v21, v7 offset:1280
  s_waitcnt lgkmcnt(0)
nz_48:
  s_barrier
  s_mov_b32 s40, s22
  s_mov_b32 s41, s23
  s_mov_b32 s42, 1152
  s_mov_b32 s43, 0x20000
  s_lshl_b32 s52, s3, 8
  s_add_u32 s52, s52, 256
  v_add_u32 v22, s52, v21
  v_mov_b32 v45, 148736
  v_mov_b32 v46, 1
  v_and_b32 v8, 1, v2
  v_lshlrev_b32 v8, 1, v8
  v_lshrrev_b32 v9, 1, v2
  v_or_b32 v8, v8, v9
  v_lshl_add_u32 v17, v3, 2, v8
  s_mov_b32 s44, 0x000f000f
  s_mov_b32 s45, 0x000f000f
  v_and_b32 v8, 7, v3
  v_lshlrev_b32 v8, 1, v8
  v_xor_b32 v8, v8, v2
  v_lshlrev_b32 v8, 4, v8
  v_lshl_add_u32 v40, v3, 8, v8
  v_xor_b32 v41, 64, v40
  v_xor_b32 v42, 0x80, v40
  v_xor_b32 v43, 0xc0, v40
  v_lshrrev_b32 v8, 2, v1
  v_and_b32 v9, 7, v8
  v_lshlrev_b32 v9, 5, v9
  v_lshl_add_u32 v9, v8, 8, v9
  v_and_b32 v8, 3, v1
  v_lshl_add_u32 v44, v8, 3, v9
  s_waitcnt vmcnt(11)
  v_lshlrev_b32 v130, 16, v124
  v_and_b32 v131, 0xffff0000, v124
  v_lshlrev_b32 v132, 16, v125
  v_and_b32 v133, 0xffff0000, v125
  v_lshlrev_b32 v134, 16, v126
  v_and_b32 v135, 0xffff0000, v126
  v_lshlrev_b32 v136, 16, v127
  v_and_b32 v137, 0xffff0000, v127
  v_lshlrev_b32 v138, 16, v128
  v_pk_add_f32 v[8:9], v[130:131], v[132:133]
  v_pk_add_f32 v[10:11], v[134:135], v[136:137]
  v_pk_add_f32 v[8:9], v[8:9], v[10:11]
  v_add_f32 v8, v8, v9
  v_add_f32 v8, v8, v138
  s_nop 1
  v_add_f32_dpp v8, v8, v8 row_ror:8 row_mask:0xf bank_mask:0xf
  s_nop 1
  v_add_f32_dpp v8, v8, v8 row_ror:4 row_mask:0xf bank_mask:0xf
  s_nop 1
  v_add_f32_dpp v8, v8, v8 row_ror:2 row_mask:0xf bank_mask:0xf
  s_nop 1
  v_add_f32_dpp v8, v8, v8 row_ror:1 row_mask:0xf bank_mask:0xf
  s_nop 1
  v_add_f32_dpp v8, v8, v8 row_bcast:15 row_mask:0xa bank_mask:0xf
  s_nop 1
  v_add_f32_dpp v8, v8, v8 row_bcast:31 row_mask:0xc bank_mask:0xf
  s_nop 0
  v_readlane_b32 s52, v8, 63
  v_mov_b32 v8, 0x3ae38e39
  s_nop 0
  v_mul_f32 v8, s52, v8
  v_sub_f32 v10, v130, v8
  v_mul_f32 v9, v10, v10
  v_sub_f32 v10, v131, v8
  v_fmac_f32 v9, v10, v10
  v_sub_f32 v10, v132, v8
  v_fmac_f32 v9, v10, v10
  v_sub_f32 v10, v133, v8
  v_fmac_f32 v9, v10, v10
  v_sub_f32 v10, v134, v8
  v_fmac_f32 v9, v10, v10
  v_sub_f32 v10, v135, v8
  v_fmac_f32 v9, v10, v10
  v_sub_f32 v10, v136, v8
  v_fmac_f32 v9, v10, v10
  v_sub_f32 v10, v137, v8
  v_fmac_f32 v9, v10, v10
  v_sub_f32 v10, v138, v8
  v_fmac_f32 v9, v10, v10
  s_nop 1
  v_add_f32_dpp v9, v9, v9 row_ror:8 row_mask:0xf bank_mask:0xf
  s_nop 1
  v_add_f32_dpp v9, v9, v9 row_ror:4 row_mask:0xf bank_mask:0xf
  s_nop 1
  v_add_f32_dpp v9, v9, v9 row_ror:2 row_mask:0xf bank_mask:0xf
  s_nop 1
  v_add_f32_dpp v9, v9, v9 row_ror:1 row_mask:0xf bank_mask:0xf
  s_nop 1
  v_add_f32_dpp v9, v9, v9 row_bcast:15 row_mask:0xa bank_mask:0xf
  s_nop 1
  v_add_f32_dpp v9, v9, v9 row_bcast:31 row_mask:0xc bank_mask:0xf
  s_nop 0
  v_readlane_b32 s52, v9, 63
  v_mov_b32 v9, 0x3ae38e39
  s_nop 0
  v_mul_f32 v9, s52, v9
  v_cvt_pk_bf16_f32 v10, v8, v9
  v_lshlrev_b32 v8, 16, v10
  v_and_b32 v9, 0xffff0000, v10
  v_add_f32 v9, 0x3727c5ac, v9
  v_cvt_pk_bf16_f32 v9, v9, v9
  v_and_b32 v9, 0xffff0000, v9
  v_sqrt_f32 v9, v9
  s_nop 0
  v_cvt_pk_bf16_f32 v9, v9, v9
  v_and_b32 v9, 0xffff0000, v9
  v_rcp_f32 v9, v9
  v_sub_f32 v130, v130, v8
  v_sub_f32 v131, v131, v8
  v_sub_f32 v132, v132, v8
  v_sub_f32 v133, v133, v8
  v_sub_f32 v134, v134, v8
  v_sub_f32 v135, v135, v8
  v_sub_f32 v136, v136, v8
  v_sub_f32 v137, v137, v8
  v_sub_f32 v138, v138, v8
  v_cvt_pk_bf16_f32 v10, v130, v131
  v_lshlrev_b32 v130, 16, v10
  v_and_b32 v131, 0xffff0000, v10
  v_cvt_pk_bf16_f32 v10, v132, v133
  v_lshlrev_b32 v132, 16, v10
  v_and_b32 v133, 0xffff0000, v10
  v_cvt_pk_bf16_f32 v10, v134, v135
  v_lshlrev_b32 v134, 16, v10
  v_and_b32 v135, 0xffff0000, v10
  v_cvt_pk_bf16_f32 v10, v136, v137
  v_lshlrev_b32 v136, 16, v10
  v_and_b32 v137, 0xffff0000, v10
  v_cvt_pk_bf16_f32 v138, v138, v138
  v_and_b32 v138, 0xffff0000, v138
  v_mul_f32 v130, v130, v9
  v_mul_f32 v131, v131, v9
  v_mul_f32 v132, v132, v9
  v_mul_f32 v133, v133, v9
  v_mul_f32 v134, v134, v9
  v_mul_f32 v135, v135, v9
  v_mul_f32 v136, v136, v9
  v_mul_f32 v137, v137, v9
  v_mul_f32 v138, v138, v9
  v_cvt_pk_bf16_f32 v10, v130, v131
  v_lshlrev_b32 v130, 16, v10
  v_and_b32 v131, 0xffff0000, v10
  v_cvt_pk_bf16_f32 v10, v132, v133
  v_lshlrev_b32 v132, 16, v10
  v_and_b32 v133, 0xffff0000, v10
  v_cvt_pk_bf16_f32 v10, v134, v135
  v_lshlrev_b32 v134, 16, v10
  v_and_b32 v135, 0xffff0000, v10
  v_cvt_pk_bf16_f32 v10, v136, v137
  v_lshlrev_b32 v136, 16, v10
  v_and_b32 v137, 0xffff0000, v10
  v_cvt_pk_bf16_f32 v138, v138, v138
  v_and_b32 v138, 0xffff0000, v138
  v_lshlrev_b32 v8, 5, v1
  v_add_u32 v8, 148992, v8
  ds_write_b128 v8, v[130:133]
  ds_write_b128 v8, v[134:137] offset:16
  v_lshlrev_b32 v8, 2, v1
  v_add_u32 v8, 151040, v8
  ds_write_b32 v8, v138
  v_add_u32 v8, s58, v2
  v_lshlrev_b32 v8, 2, v8
  v_add_u32 v8, 148992, v8
  s_waitcnt lgkmcnt(0)
  ds_read_b32 v130, v8 offset:0
  ds_read_b32 v131, v8 offset:16
  ds_read_b32 v132, v8 offset:32
  ds_read_b32 v133, v8 offset:48
  ds_read_b32 v134, v8 offset:64
  ds_read_b32 v135, v8 offset:80
  ds_read_b32 v136, v8 offset:96
  ds_read_b32 v137, v8 offset:112
  ds_read_b32 v138, v8 offset:128
  v_mov_b32 v12, 0
  v_mov_b32 v13, 0
  v_mov_b32 v14, 0
  v_mov_b32 v15, 0
  s_lshl_b32 s52, s3, 8
  s_add_u32 s52, s52, 151296
  v_lshl_add_u32 v6, v17, 2, s52
  s_waitcnt lgkmcnt(0)
  s_waitcnt vmcnt(10)
  v_lshlrev_b32 v8, 16, v106
  v_and_b32 v9, 0xffff0000, v106
  v_lshlrev_b32 v10, 16, v107
  v_and_b32 v11, 0xffff0000, v107
  v_fmac_f32 v12, v8, v130
  v_fmac_f32 v13, v9, v130
  v_fmac_f32 v14, v10, v130
  v_fmac_f32 v15, v11, v130
  s_waitcnt vmcnt(9)
  v_lshlrev_b32 v8, 16, v108
  v_and_b32 v9, 0xffff0000, v108
  v_lshlrev_b32 v10, 16, v109
  v_and_b32 v11, 0xffff0000, v109
  v_fmac_f32 v12, v8, v131
  v_fmac_f32 v13, v9, v131
  v_fmac_f32 v14, v10, v131
  v_fmac_f32 v15, v11, v131
  s_waitcnt vmcnt(8)
  v_lshlrev_b32 v8, 16, v110
  v_and_b32 v9, 0xffff0000, v110
  v_lshlrev_b32 v10, 16, v111
  v_and_b32 v11, 0xffff0000, v111
  v_fmac_f32 v12, v8, v132
  v_fmac_f32 v13, v9, v132
  v_fmac_f32 v14, v10, v132
  v_fmac_f32 v15, v11, v132
  s_waitcnt vmcnt(7)
  v_lshlrev_b32 v8, 16, v112
  v_and_b32 v9, 0xffff0000, v112
  v_lshlrev_b32 v10, 16, v113
  v_and_b32 v11, 0xffff0000, v113
  v_fmac_f32 v12, v8, v133
  v_fmac_f32 v13, v9, v133
  v_fmac_f32 v14, v10, v133
  v_fmac_f32 v15, v11, v133
  s_waitcnt vmcnt(6)
  v_lshlrev_b32 v8, 16, v114
  v_and_b32 v9, 0xffff0000, v114
  v_lshlrev_b32 v10, 16, v115
  v_and_b32 v11, 0xffff0000, v115
  v_fmac_f32 v12, v8, v134
  v_fmac_f32 v13, v9, v134
  v_fmac_f32 v14, v10, v134
  v_fmac_f32 v15, v11, v134
  s_waitcnt vmcnt(5)
  v_lshlrev_b32 v8, 16, v116
  v_and_b32 v9, 0xffff0000, v116
  v_lshlrev_b32 v10, 16, v117
  v_and_b32 v11, 0xffff0000, v117
  v_fmac_f32 v12, v8, v135
  v_fmac_f32 v13, v9, v135
  v_fmac_f32 v14, v10, v135
  v_fmac_f32 v15, v11, v135
  s_waitcnt vmcnt(4)
  v_lshlrev_b32 v8, 16, v118
  v_and_b32 v9, 0xffff0000, v118
  v_lshlrev_b32 v10, 16, v119
  v_and_b32 v11, 0xffff0000, v119
  v_fmac_f32 v12, v8, v136
  v_fmac_f32 v13, v9, v136
  v_fmac_f32 v14, v10, v136
  v_fmac_f32 v15, v11, v136
  s_waitcnt vmcnt(3)
  v_lshlrev_b32 v8, 16, v120
  v_and_b32 v9, 0xffff0000, v120
  v_lshlrev_b32 v10, 16, v121
  v_and_b32 v11, 0xffff0000, v121
  v_fmac_f32 v12, v8, v137
  v_fmac_f32 v13, v9, v137
  v_fmac_f32 v14, v10, v137
  v_fmac_f32 v15, v11, v137
  s_waitcnt vmcnt(2)
  v_lshlrev_b32 v8, 16, v122
  v_and_b32 v9, 0xffff0000, v122
  v_lshlrev_b32 v10, 16, v123
  v_and_b32 v11, 0xffff0000, v123
  v_fmac_f32 v12, v8, v138
  v_fmac_f32 v13, v9, v138
  v_fmac_f32 v14, v10, v138
  v_fmac_f32 v15, v11, v138
  v_permlane32_swap_b32 v12, v13
  s_nop 0
  v_permlane32_swap_b32 v14, v15
  v_add_f32 v12, v12, v13
  v_add_f32 v14, v14, v15
  s_nop 1
  v_permlane16_swap_b32 v12, v14
  v_add_f32 v12, v12, v14
  ds_write_b32 v6, v12
  s_waitcnt vmcnt(1)
  v_add_u32 v16, 0x9e3779b9, v16
  s_mov_b64 exec, 1
  ds_add_rtn_u32 v5, v45, v46 offset:0
  s_waitcnt lgkmcnt(0)
  v_readfirstlane_b32 s52, v5
  s_mov_b64 exec, -1
  s_cmp_lg_u32 s52, 3
  s_cbranch_scc1 qnl_49
  v_lshlrev_b32 v8, 2, v1
  v_add_u32 v8, 151296, v8
  ds_read_b32 v12, v8
  ds_read_b32 v13, v8 offset:256
  ds_read_b32 v14, v8 offset:512
  ds_read_b32 v15, v8 offset:768
  s_lshl_b32 s52, s1, 9
  s_add_u32 s52, s52, 65536
  v_lshlrev_b32 v8, 3, v1
  s_waitcnt lgkmcnt(0)
  v_add_f32 v12, v12, v13
  v_add_f32 v14, v14, v15
  v_add_f32 v12, v12, v14
  v_mov_b32 v13, v16
  buffer_store_dwordx2 v[12:13], v8, s[28:31], s52 offen sc0 sc1
qnl_49:
  s_mov_b32 s58, s3
  s_lshl_b32 s59, s3, 13
  s_mov_b32 s60, 0
  s_mov_b32 s46, 0x00030003
  s_mov_b32 s47, 0x00030003
  v_mov_b32 v47, 0xff61b1e6
  v_mov_b32 v48, 0
  s_getreg_b32 s49, hwreg(HW_REG_XCC_ID, 0, 3)
  s_lshl_b32 s48, s49, 12
  s_add_u32 s48, s48, 1179648
  s_lshl_b32 s50, s55, 2
  s_add_u32 s50, s50, s48
  v_lshlrev_b32 v246, 2, v1
  v_lshlrev_b32 v245, 2, v1
  s_cmp_lt_u32 s2, 72
  s_cselect_b32 s97, 8, 8
  s_cmp_ge_u32 s2, 112
  s_cselect_b32 s97, 8, s97
  s_bitcmp1_b32 s2, 0
  s_cselect_b64 s[98:99], -1, 0
  s_bitcmp1_b32 s2, 1
  s_cselect_b64 s[100:101], -1, 0
  v_add_u32 v248, 0x800, v16
  v_add_u32 v249, 0x800, v16
  v_add_u32 v250, 0x800, v16
  v_add_u32 v251, 0x800, v16
  v_add_u32 v252, 0x800, v16
  v_add_u32 v253, 0x800, v16
  s_add_u32 s61, s58, 1
spin_50:
  ds_read_b32 v4, v21 offset:0
  s_waitcnt lgkmcnt(0)
  v_readfirstlane_b32 s52, v4
  s_nop 0
  s_cmp_ge_i32 s52, s61
  s_cbranch_scc1 done_51
  s_sub_u32 s62, s62, 1
  s_cbranch_scc1 L_end
  s_branch spin_50
done_51:
  s_mov_b32 s63, s52
  v_add_u32 v50, s59, v40
  v_add_u32 v51, s59, v41
  v_add_u32 v52, s59, v42
  v_add_u32 v53, s59, v43
  ds_read_b128 v[210:213], v50 offset:0
  ds_read_b128 v[214:217], v51 offset:0
  ds_read_b128 v[218:221], v52 offset:0
  ds_read_b128 v[222:225], v53 offset:0
  ds_read_b128 v[226:229], v50 offset:4096
  ds_read_b128 v[230:233], v51 offset:4096
  ds_read_b128 v[234:237], v52 offset:4096
  ds_read_b128 v[238:241], v53 offset:4096
  s_add_u32 s60, s60, 1
  v_mov_b32 v4, s60
  s_waitcnt lgkmcnt(0)
  ds_write_b32 v22, v4
  s_add_u32 s58, s58, 4
  s_add_u32 s59, s59, 32768
  s_cmp_ge_u32 s59, 147456
  s_cselect_b32 s52, 147456, 0
  s_sub_u32 s59, s59, s52
  s_add_u32 s61, s58, 1
spin_52:
  ds_read_b32 v4, v21 offset:0
  s_waitcnt lgkmcnt(0)
  v_readfirstlane_b32 s52, v4
  s_nop 0
  s_cmp_ge_i32 s52, s61
  s_cbranch_scc1 done_53
  s_sub_u32 s62, s62, 1
  s_cbranch_scc1 L_end
  s_branch spin_52
done_53:
  s_mov_b32 s63, s52
  v_add_u32 v50, s59, v40
  v_add_u32 v51, s59, v41
  v_add_u32 v52, s59, v42
  v_add_u32 v53, s59, v43
  ds_read_b128 v[58:61], v50 offset:0
  ds_read_b128 v[62:65], v51 offset:0
  ds_read_b128 v[66:69], v52 offset:0
  ds_read_b128 v[70:73], v53 offset:0
  ds_read_b128 v[74:77], v50 offset:4096
  ds_read_b128 v[78:81], v51 offset:4096
  ds_read_b128 v[82:85], v52 offset:4096
  ds_read_b128 v[86:89], v53 offset:4096
  s_add_u32 s60, s60, 1
  v_mov_b32 v4, s60
  s_waitcnt lgkmcnt(0)
  ds_write_b32 v22, v4
  s_add_u32 s58, s58, 4
  s_add_u32 s59, s59, 32768
  s_cmp_ge_u32 s59, 147456
  s_cselect_b32 s52, 147456, 0
  s_sub_u32 s59, s59, s52
  s_lshl_b32 s52, s57, 13
  s_lshl_b32 s53, s3, 11
  s_add_u32 s61, s52, s53
  s_add_u32 s61, s61, 65536
  v_lshlrev_b32 v8, 3, v1
qg_54:
  buffer_load_dwordx2 v[106:107], v8, s[28:31], s61 offen offset:0 sc0 sc1
  buffer_load_dwordx2 v[108:109], v8, s[28:31], s61 offen offset:512 sc0 sc1
  buffer_load_dwordx2 v[110:111], v8, s[28:31], s61 offen offset:1024 sc0 sc1
  buffer_load_dwordx2 v[112:113], v8, s[28:31], s61 offen offset:1536 sc0 sc1
qw_56:
  s_waitcnt vmcnt(0)
  v_xor_b32 v12, v107, v16
  v_xor_b32 v13, v109, v16
  v_xor_b32 v14, v111, v16
  v_xor_b32 v15, v113, v16
  v_or3_b32 v12, v12, v13, v14
  v_or_b32 v12, v12, v15
  v_cmp_ne_u32 vcc, 0, v12
  s_cbranch_vccz qgd_55
  s_sub_u32 s62, s62, 1
  s_cbranch_scc1 L_end
  s_branch qg_54
qgd_55:
  v_add_f32 v12, v106, v108
  v_add_f32 v13, v110, v112
  v_add_f32 v12, v12, v13
  v_cvt_pk_bf16_f32 v12, v12, v12
  s_lshl_b32 s52, s3, 7
  s_add_u32 s52, s52, 152320
  v_lshl_add_u32 v8, v1, 1, s52
  ds_write_b16 v8, v12
  v_and_b32 v8, 1, v3
  v_lshlrev_b32 v8, 8, v8
  v_lshl_add_u32 v8, v2, 4, v8
  v_add_u32 v8, 152320, v8
  s_mov_b64 exec, 1
  ds_add_rtn_u32 v5, v45, v46 offset:4
  s_waitcnt lgkmcnt(0)
  v_readfirstlane_b32 s52, v5
  s_mov_b64 exec, -1
  s_cmp_eq_u32 s52, 3
  s_cbranch_scc1 go_57
spin_58:
  ds_read_b32 v5, v45 offset:4
  s_waitcnt lgkmcnt(0)
  v_readfirstlane_b32 s52, v5
  s_nop 0
  s_cmp_ge_i32 s52, 4
  s_cbranch_scc1 done_59
  s_sub_u32 s62, s62, 1
  s_cbranch_scc1 L_end
  s_branch spin_58
done_59:
go_57:
  ds_read_b128 v[24:27], v8 offset:0
  ds_read_b128 v[28:31], v8 offset:64
  ds_read_b128 v[32:35], v8 offset:128
  ds_read_b128 v[36:39], v8 offset:192
  s_mul_i32 s52, s3, 144
  v_add_u32 v8, s52, v17
  v_lshlrev_b32 v8, 1, v8
  v_mov_b32 v9, 2147483632
  v_cndmask_b32 v10, v9, v8, s[44:45]
  buffer_load_ushort v18, v8, s[32:35], 0 offen
  buffer_load_ushort v19, v8, s[32:35], 0 offen offset:128
  buffer_load_ushort v20, v10, s[32:35], 0 offen offset:256
  s_sub_u32 s52, s2, 72
  s_lshl_b32 s52, s52, 4
  v_and_b32 v8, 15, v17
  v_add_u32 v8, s52, v8
  v_lshlrev_b32 v8, 1, v8
  v_min_u32 v23, 2147483632, v8
  buffer_load_ushort v247, v23, s[32:35], 0 offen
  s_waitcnt lgkmcnt(0)
  v_mfma_f32_16x16x32_bf16 v[90:93], v[210:213], v[24:27], 0
  v_mfma_f32_16x16x32_bf16 v[94:97], v[226:229], v[24:27], 0
  v_mfma_f32_16x16x32_bf16 v[90:93], v[214:217], v[28:31], v[90:93]
  v_mfma_f32_16x16x32_bf16 v[94:97], v[230:233], v[28:31], v[94:97]
  v_mfma_f32_16x16x32_bf16 v[90:93], v[218:221], v[32:35], v[90:93]
  v_mfma_f32_16x16x32_bf16 v[94:97], v[234:237], v[32:35], v[94:97]
  v_mfma_f32_16x16x32_bf16 v[90:93], v[222:225], v[36:39], v[90:93]
  v_mfma_f32_16x16x32_bf16 v[94:97], v[238:241], v[36:39], v[94:97]
  s_nop 6
  v_cndmask_b32 v98, v98, v90, s[46:47]
  v_cndmask_b32 v99, v99, v91, s[46:47]
  v_cndmask_b32 v100, v100, v92, s[46:47]
  v_cndmask_b32 v101, v101, v93, s[46:47]
  v_cndmask_b32 v102, v102, v94, s[46:47]
  v_cndmask_b32 v103, v103, v95, s[46:47]
  v_cndmask_b32 v104, v104, v96, s[46:47]
  v_cndmask_b32 v105, v105, v97, s[46:47]
  s_lshl_b64 s[46:47], s[46:47], 2
  v_mfma_f32_16x16x32_bf16 v[90:93], v[58:61], v[24:27], 0
  v_mfma_f32_16x16x32_bf16 v[94:97], v[74:77], v[24:27], 0
  v_mfma_f32_16x16x32_bf16 v[90:93], v[62:65], v[28:31], v[90:93]
  v_mfma_f32_16x16x32_bf16 v[94:97], v[78:81], v[28:31], v[94:97]
  v_mfma_f32_16x16x32_bf16 v[90:93], v[66:69], v[32:35], v[90:93]
  v_mfma_f32_16x16x32_bf16 v[94:97], v[82:85], v[32:35], v[94:97]
  v_mfma_f32_16x16x32_bf16 v[90:93], v[70:73], v[36:39], v[90:93]
  v_mfma_f32_16x16x32_bf16 v[94:97], v[86:89], v[36:39], v[94:97]
  s_nop 6
  v_cndmask_b32 v98, v98, v90, s[46:47]
  v_cndmask_b32 v99, v99, v91, s[46:47]
  v_cndmask_b32 v100, v100, v92, s[46:47]
  v_cndmask_b32 v101, v101, v93, s[46:47]
  v_cndmask_b32 v102, v102, v94, s[46:47]
  v_cndmask_b32 v103, v103, v95, s[46:47]
  v_cndmask_b32 v104, v104, v96, s[46:47]
  v_cndmask_b32 v105, v105, v97, s[46:47]
  s_lshl_b64 s[46:47], s[46:47], 2
kl_60:
  s_add_u32 s61, s58, 1
spin_62:
  ds_read_b32 v4, v21 offset:0
  s_waitcnt lgkmcnt(0)
  v_readfirstlane_b32 s52, v4
  s_nop 0
  s_cmp_ge_i32 s52, s61
  s_cbranch_scc1 done_63
  s_sub_u32 s62, s62, 1
  s_cbranch_scc1 L_end
  s_branch spin_62
done_63:
  s_mov_b32 s63, s52
  v_add_u32 v50, s59, v40
  v_add_u32 v51, s59, v41
  v_add_u32 v52, s59, v42
  v_add_u32 v53, s59, v43
  ds_read_b128 v[58:61], v50 offset:0
  ds_read_b128 v[62:65], v51 offset:0
  ds_read_b128 v[66:69], v52 offset:0
  ds_read_b128 v[70:73], v53 offset:0
  ds_read_b128 v[74:77], v50 offset:4096
  ds_read_b128 v[78:81], v51 offset:4096
  ds_read_b128 v[82:85], v52 offset:4096
  ds_read_b128 v[86:89], v53 offset:4096
  s_add_u32 s60, s60, 1
  v_mov_b32 v4, s60
  s_waitcnt lgkmcnt(0)
  ds_write_b32 v22, v4
  v_mfma_f32_16x16x32_bf16 v[90:93], v[58:61], v[24:27], 0
  v_mfma_f32_16x16x32_bf16 v[94:97], v[74:77], v[24:27], 0
  v_mfma_f32_16x16x32_bf16 v[90:93], v[62:65], v[28:31], v[90:93]
  v_mfma_f32_16x16x32_bf16 v[94:97], v[78:81], v[28:31], v[94:97]
  v_mfma_f32_16x16x32_bf16 v[90:93], v[66:69], v[32:35], v[90:93]
  v_mfma_f32_16x16x32_bf16 v[94:97], v[82:85], v[32:35], v[94:97]
  v_mfma_f32_16x16x32_bf16 v[90:93], v[70:73], v[36:39], v[90:93]
  v_mfma_f32_16x16x32_bf16 v[94:97], v[86:89], v[36:39], v[94:97]
  s_add_u32 s58, s58, 4
  s_add_u32 s59, s59, 32768
  s_cmp_ge_u32 s59, 147456
  s_cselect_b32 s52, 147456, 0
  s_sub_u32 s59, s59, s52
  s_nop 1
  v_cndmask_b32 v98, v98, v90, s[46:47]
  v_cndmask_b32 v99, v99, v91, s[46:47]
  v_cndmask_b32 v100, v100, v92, s[46:47]
  v_cndmask_b32 v101, v101, v93, s[46:47]
  v_cndmask_b32 v102, v102, v94, s[46:47]
  v_cndmask_b32 v103, v103, v95, s[46:47]
  v_cndmask_b32 v104, v104, v96, s[46:47]
  v_cndmask_b32 v105, v105, v97, s[46:47]
  s_lshl_b64 s[46:47], s[46:47], 2
  s_lshr_b32 s52, 1, s3
  s_bitcmp0_b32 s52, 0
  s_cbranch_scc1 pg_64
  s_add_u32 s52, s63, s97
  v_add_u32 v5, s52, v16
  s_bfm_b64 exec, 1, 0
  buffer_store_dword v5, v7, s[28:31], s50 offen sc0
  s_mov_b64 exec, -1
  s_branch pgx_65
pg_64:
  s_cmp_lg_u32 s3, 2
  s_cbranch_scc1 pgx_65
  s_waitcnt vmcnt(0)
  v_sub_u32 v5, v248, v16
  s_bfm_b64 exec, 32, 0
  buffer_load_dword v248, v246, s[28:31], s48 offen sc1
  s_mov_b64 exec, -1
  v_readlane_b32 s52, v5, s55
  s_bfm_b64 exec, 32, 0
  v_cmp_gt_u32 vcc, 0x200, v5
  s_mov_b64 exec, -1
  v_subrev_u32 v5, s52, v5
  s_bcnt1_i32_b64 s61, vcc
  s_cmp_ge_u32 s52, 0x200
  s_cbranch_scc1 pgx_65
  v_cndmask_b32 v5, v7, v5, vcc
  s_nop 1
  v_add_u32_dpp v5, v5, v5 row_ror:8 row_mask:0xf bank_mask:0xf
  s_nop 1
  v_add_u32_dpp v5, v5, v5 row_ror:4 row_mask:0xf bank_mask:0xf
  s_nop 1
  v_add_u32_dpp v5, v5, v5 row_ror:2 row_mask:0xf bank_mask:0xf
  s_nop 1
  v_add_u32_dpp v5, v5, v5 row_ror:1 row_mask:0xf bank_mask:0xf
  s_nop 1
  v_add_u32_dpp v5, v5, v5 row_bcast:15 row_mask:0xa bank_mask:0xf
  s_nop 1
  v_add_u32_dpp v5, v5, v5 row_bcast:31 row_mask:0xc bank_mask:0xf
  s_nop 0
  v_readlane_b32 s96, v5, 63
  s_mov_b32 s53, 3
  s_lshl_b32 s96, s96, 6
  s_mul_i32 s52, s61, 44
  s_cmp_gt_i32 s96, s52
  s_cselect_b32 s53, 4, s53
  s_sub_i32 s52, 0, s52
  s_cmp_lt_i32 s96, s52
  s_cselect_b32 s53, 2, s53
  s_mul_i32 s52, s61, 128
  s_cmp_gt_i32 s96, s52
  s_cselect_b32 s53, 5, s53
  s_sub_i32 s52, 0, s52
  s_cmp_lt_i32 s96, s52
  s_cselect_b32 s53, 1, s53
  v_mov_b32 v5, s53
  s_mov_b64 exec, 1
  ds_write_b32 v45, v5 offset:32
  s_mov_b64 exec, -1
pgx_65:
  s_and_b32 s52, s60, 7
  s_cbranch_scc1 kl_60
  s_mov_b32 s46, 0x00030003
  s_mov_b32 s47, 0x00030003
  v_mov_b32 v106, v114
  v_mov_b32 v107, v115
  v_mov_b32 v108, v116
  v_mov_b32 v109, v117
  v_mov_b32 v110, v118
  v_mov_b32 v111, v119
  v_mov_b32 v112, v120
  v_mov_b32 v113, v121
  v_mov_b32 v114, v122
  v_mov_b32 v115, v123
  v_mov_b32 v116, v124
  v_mov_b32 v117, v125
  v_mov_b32 v118, v126
  v_mov_b32 v119, v127
  v_mov_b32 v120, v128
  v_mov_b32 v121, v129
  v_mov_b32 v122, v130
  v_mov_b32 v123, v131
  v_mov_b32 v124, v132
  v_mov_b32 v125, v133
  v_mov_b32 v126, v134
  v_mov_b32 v127, v135
  v_mov_b32 v128, v136
  v_mov_b32 v129, v137
  v_cvt_pk_bf16_f32 v4, v98, v99
  v_lshlrev_b32 v98, 16, v4
  v_and_b32 v99, 0xffff0000, v4
  v_cvt_pk_bf16_f32 v4, v100, v101
  v_lshlrev_b32 v100, 16, v4
  v_and_b32 v101, 0xffff0000, v4
  v_cvt_pk_bf16_f32 v4, v102, v103
  v_lshlrev_b32 v102, 16, v4
  v_and_b32 v103, 0xffff0000, v4
  v_cvt_pk_bf16_f32 v4, v104, v105
  v_lshlrev_b32 v104, 16, v4
  v_and_b32 v105, 0xffff0000, v4
  v_mul_f32 v130, 0x3db504f3, v98
  v_mul_f32 v131, 0x3db504f3, v99
  v_mul_f32 v132, 0x3db504f3, v100
  v_mul_f32 v133, 0x3db504f3, v101
  v_mul_f32 v134, 0x3db504f3, v102
  v_mul_f32 v135, 0x3db504f3, v103
  v_mul_f32 v136, 0x3db504f3, v104
  v_mul_f32 v137, 0x3db504f3, v105
  v_cvt_pk_bf16_f32 v4, v130, v131
  v_lshlrev_b32 v130, 16, v4
  v_and_b32 v131, 0xffff0000, v4
  v_cvt_pk_bf16_f32 v4, v132, v133
  v_lshlrev_b32 v132, 16, v4
  v_and_b32 v133, 0xffff0000, v4
  v_cvt_pk_bf16_f32 v4, v134, v135
  v_lshlrev_b32 v134, 16, v4
  v_and_b32 v135, 0xffff0000, v4
  v_cvt_pk_bf16_f32 v4, v136, v137
  v_lshlrev_b32 v136, 16, v4
  v_and_b32 v137, 0xffff0000, v4
  v_max3_f32 v8, v47, v130, v131
  v_max3_f32 v8, v8, v132, v133
  v_max3_f32 v8, v8, v134, v135
  v_max3_f32 v8, v8, v136, v137
  v_sub_f32 v9, v47, v8
  v_mov_b32 v47, v8
  v_sub_f32 v98, v130, v8
  v_sub_f32 v99, v131, v8
  v_sub_f32 v100, v132, v8
  v_sub_f32 v101, v133, v8
  v_sub_f32 v102, v134, v8
  v_sub_f32 v103, v135, v8
  v_sub_f32 v104, v136, v8
  v_sub_f32 v105, v137, v8
  v_mul_f32 v9, 0x3fb8aa3b, v9
  v_mul_f32 v98, 0x3fb8aa3b, v98
  v_mul_f32 v99, 0x3fb8aa3b, v99
  v_mul_f32 v100, 0x3fb8aa3b, v100
  v_mul_f32 v101, 0x3fb8aa3b, v101
  v_mul_f32 v102, 0x3fb8aa3b, v102
  v_mul_f32 v103, 0x3fb8aa3b, v103
  v_mul_f32 v104, 0x3fb8aa3b, v104
  v_mul_f32 v105, 0x3fb8aa3b, v105
  v_exp_f32 v9, v9
  v_exp_f32 v98, v98
  v_exp_f32 v99, v99
  v_exp_f32 v100, v100
  v_exp_f32 v101, v101
  v_exp_f32 v102, v102
  v_exp_f32 v103, v103
  v_exp_f32 v104, v104
  v_exp_f32 v105, v105
  v_mul_f32 v48, v48, v9
  v_pk_add_f32 v[98:99], v[98:99], v[100:101]
  v_pk_add_f32 v[102:103], v[102:103], v[104:105]
  v_pk_add_f32 v[98:99], v[98:99], v[102:103]
  v_add_f32 v48, v48, v98
  v_add_f32 v48, v48, v99
  s_cmp_lg_u32 s60, 32
  s_cbranch_scc1 kl_60
  v_mov_b32 v8, v47
  s_nop 1
  v_max_f32_dpp v8, v8, v8 row_ror:8 row_mask:0xf bank_mask:0xf
  s_nop 1
  v_max_f32_dpp v8, v8, v8 row_ror:4 row_mask:0xf bank_mask:0xf
  s_nop 1
  v_max_f32_dpp v8, v8, v8 row_ror:2 row_mask:0xf bank_mask:0xf
  v_mov_b32 v4, v8
  s_nop 1
  v_permlane16_swap_b32 v4, v8
  v_max_f32 v8, v8, v4
  v_mov_b32 v4, v8
  s_nop 1
  v_permlane32_swap_b32 v4, v8
  v_max_f32 v8, v8, v4
  v_sub_f32 v9, v47, v8
  v_mul_f32 v9, 0x3fb8aa3b, v9
  v_exp_f32 v9, v9
  s_lshl_b32 s53, s3, 4
  s_add_u32 s53, s53, 157952
  v_mul_f32 v9, v9, v48
  s_nop 1
  v_add_f32_dpp v9, v9, v9 row_ror:8 row_mask:0xf bank_mask:0xf
  s_nop 1
  v_add_f32_dpp v9, v9, v9 row_ror:4 row_mask:0xf bank_mask:0xf
  s_nop 1
  v_add_f32_dpp v9, v9, v9 row_ror:2 row_mask:0xf bank_mask:0xf
  v_mov_b32 v4, v9
  s_nop 1
  v_permlane16_swap_b32 v4, v9
  v_add_f32 v9, v9, v4
  v_mov_b32 v4, v9
  s_nop 1
  v_permlane32_swap_b32 v4, v9
  v_add_f32 v9, v9, v4
  v_lshlrev_b32 v6, 3, v1
  v_add_u32 v4, s53, v6
  s_mov_b64 exec, 3
  ds_write_b64 v4, v[8:9]
  s_mov_b64 exec, 1
  ds_add_rtn_u32 v5, v45, v46 offset:28
  s_waitcnt lgkmcnt(0)
  v_readfirstlane_b32 s52, v5
  s_mov_b64 exec, -1
  s_cmp_lg_u32 s52, 3
  s_cbranch_scc1 mnl_68
  v_add_u32 v4, 157952, v6
  s_mov_b64 exec, 3
  ds_read_b64 v[98:99], v4 offset:0
  ds_read_b64 v[100:101], v4 offset:16
  ds_read_b64 v[102:103], v4 offset:32
  ds_read_b64 v[104:105], v4 offset:48
  s_lshl_b32 s53, s1, 5
  s_add_u32 s53, s53, 262144
  v_lshlrev_b32 v6, 4, v1
  v_mov_b32 v13, v16
  v_mov_b32 v15, v16
  s_waitcnt lgkmcnt(0)
  v_max_f32 v12, v98, v100
  v_max3_f32 v12, v12, v102, v104
  v_sub_f32 v98, v98, v12
  v_sub_f32 v100, v100, v12
  v_sub_f32 v102, v102, v12
  v_sub_f32 v104, v104, v12
  v_mul_f32 v98, 0x3fb8aa3b, v98
  v_mul_f32 v100, 0x3fb8aa3b, v100
  v_mul_f32 v102, 0x3fb8aa3b, v102
  v_mul_f32 v104, 0x3fb8aa3b, v104
  v_exp_f32 v98, v98
  v_exp_f32 v100, v100
  v_exp_f32 v102, v102
  v_exp_f32 v104, v104
  v_mul_f32 v14, v98, v99
  v_fmac_f32 v14, v100, v101
  v_fmac_f32 v14, v102, v103
  v_fmac_f32 v14, v104, v105
  buffer_store_dwordx4 v[12:15], v6, s[28:31], s53 offen sc0 sc1
  s_mov_b64 exec, -1
mnl_68:
  v_mov_b32 v142, 0
  v_mov_b32 v143, 0
  v_mov_b32 v144, 0
  v_mov_b32 v145, 0
  s_lshr_b32 s52, s2, 3
  s_mul_i32 s52, s52, 18
  s_lshr_b32 s53, s3, 1
  s_mul_i32 s53, s53, 9
  s_add_u32 s52, s52, s53
  s_mul_i32 s52, s52, 9216
  s_and_b32 s53, s2, 7
  s_mul_i32 s53, s53, 1152
  s_add_u32 s52, s52, s53
  s_bitcmp1_b32 s3, 0
  s_cselect_b32 s34, s18, s16
  s_cselect_b32 s35, s19, s17
  s_add_u32 s32, s34, s52
  s_addc_u32 s33, s35, 0
  s_mov_b32 s34, 74880
  s_mov_b32 s35, 0x20000
  v_add_u32 v50, s59, v44
  v_xor_b32 v51, 0x20, v50
  v_xor_b32 v52, 0x40, v50
  v_xor_b32 v53, 0x60, v50
  v_xor_b32 v54, 0x80, v50
  v_xor_b32 v55, 0xa0, v50
  v_xor_b32 v56, 0xc0, v50
  v_xor_b32 v57, 0xe0, v50
  s_add_u32 s61, s58, 1
spin_69:
  ds_read_b32 v4, v21 offset:0
  s_waitcnt lgkmcnt(0)
  v_readfirstlane_b32 s52, v4
  s_nop 0
  s_cmp_ge_i32 s52, s61
  s_cbranch_scc1 done_70
  s_sub_u32 s62, s62, 1
  s_cbranch_scc1 L_end
  s_branch spin_69
done_70:
  s_mov_b32 s63, s52
  ds_read_b64_tr_b16 v[210:211], v50 offset:0
  ds_read_b64_tr_b16 v[212:213], v50 offset:4096
  ds_read_b64_tr_b16 v[214:215], v51 offset:0
  ds_read_b64_tr_b16 v[216:217], v51 offset:4096
  ds_read_b64_tr_b16 v[218:219], v52 offset:0
  ds_read_b64_tr_b16 v[220:221], v52 offset:4096
  ds_read_b64_tr_b16 v[222:223], v53 offset:0
  ds_read_b64_tr_b16 v[224:225], v53 offset:4096
  ds_read_b64_tr_b16 v[226:227], v54 offset:0
  ds_read_b64_tr_b16 v[228:229], v54 offset:4096
  ds_read_b64_tr_b16 v[230:231], v55 offset:0
  ds_read_b64_tr_b16 v[232:233], v55 offset:4096
  ds_read_b64_tr_b16 v[234:235], v56 offset:0
  ds_read_b64_tr_b16 v[236:237], v56 offset:4096
  ds_read_b64_tr_b16 v[238:239], v57 offset:0
  ds_read_b64_tr_b16 v[240:241], v57 offset:4096
  s_add_u32 s60, s60, 1
  v_mov_b32 v4, s60
  s_waitcnt lgkmcnt(0)
  ds_write_b32 v22, v4
  s_add_u32 s58, s58, 4
  s_add_u32 s59, s59, 32768
  s_cmp_ge_u32 s59, 147456
  s_cselect_b32 s52, 147456, 0
  s_sub_u32 s59, s59, s52
  s_lshr_b32 s52, 1, s3
  s_bitcmp0_b32 s52, 0
  s_cbranch_scc1 pg_71
  s_add_u32 s52, s63, s97
  v_add_u32 v5, s52, v16
  s_bfm_b64 exec, 1, 0
  buffer_store_dword v5, v7, s[28:31], s50 offen sc0
  s_mov_b64 exec, -1
  s_branch pgx_72
pg_71:
  s_cmp_lg_u32 s3, 2
  s_cbranch_scc1 pgx_72
  s_waitcnt vmcnt(0)
  v_sub_u32 v5, v248, v16
  s_bfm_b64 exec, 32, 0
  buffer_load_dword v248, v246, s[28:31], s48 offen sc1
  s_mov_b64 exec, -1
  v_readlane_b32 s52, v5, s55
  s_bfm_b64 exec, 32, 0
  v_cmp_gt_u32 vcc, 0x200, v5
  s_mov_b64 exec, -1
  v_subrev_u32 v5, s52, v5
  s_bcnt1_i32_b64 s61, vcc
  s_cmp_ge_u32 s52, 0x200
  s_cbranch_scc1 pgx_72
  v_cndmask_b32 v5, v7, v5, vcc
  s_nop 1
  v_add_u32_dpp v5, v5, v5 row_ror:8 row_mask:0xf bank_mask:0xf
  s_nop 1
  v_add_u32_dpp v5, v5, v5 row_ror:4 row_mask:0xf bank_mask:0xf
  s_nop 1
  v_add_u32_dpp v5, v5, v5 row_ror:2 row_mask:0xf bank_mask:0xf
  s_nop 1
  v_add_u32_dpp v5, v5, v5 row_ror:1 row_mask:0xf bank_mask:0xf
  s_nop 1
  v_add_u32_dpp v5, v5, v5 row_bcast:15 row_mask:0xa bank_mask:0xf
  s_nop 1
  v_add_u32_dpp v5, v5, v5 row_bcast:31 row_mask:0xc bank_mask:0xf
  s_nop 0
  v_readlane_b32 s96, v5, 63
  s_mov_b32 s53, 3
  s_lshl_b32 s96, s96, 6
  s_mul_i32 s52, s61, 44
  s_cmp_gt_i32 s96, s52
  s_cselect_b32 s53, 4, s53
  s_sub_i32 s52, 0, s52
  s_cmp_lt_i32 s96, s52
  s_cselect_b32 s53, 2, s53
  s_mul_i32 s52, s61, 128
  s_cmp_gt_i32 s96, s52
  s_cselect_b32 s53, 5, s53
  s_sub_i32 s52, 0, s52
  s_cmp_lt_i32 s96, s52
  s_cselect_b32 s53, 1, s53
  v_mov_b32 v5, s53
  s_mov_b64 exec, 1
  ds_write_b32 v45, v5 offset:32
  s_mov_b64 exec, -1
pgx_72:
  v_add_u32 v50, s59, v44
  v_xor_b32 v51, 0x20, v50
  v_xor_b32 v52, 0x40, v50
  v_xor_b32 v53, 0x60, v50
  v_xor_b32 v54, 0x80, v50
  v_xor_b32 v55, 0xa0, v50
  v_xor_b32 v56, 0xc0, v50
  v_xor_b32 v57, 0xe0, v50
  s_add_u32 s61, s58, 1
spin_73:
  ds_read_b32 v4, v21 offset:0
  s_waitcnt lgkmcnt(0)
  v_readfirstlane_b32 s52, v4
  s_nop 0
  s_cmp_ge_i32 s52, s61
  s_cbranch_scc1 done_74
  s_sub_u32 s62, s62, 1
  s_cbranch_scc1 L_end
  s_branch spin_73
done_74:
  s_mov_b32 s63, s52
  ds_read_b64_tr_b16 v[58:59], v50 offset:0
  ds_read_b64_tr_b16 v[60:61], v50 offset:4096
  ds_read_b64_tr_b16 v[62:63], v51 offset:0
  ds_read_b64_tr_b16 v[64:65], v51 offset:4096
  ds_read_b64_tr_b16 v[66:67], v52 offset:0
  ds_read_b64_tr_b16 v[68:69], v52 offset:4096
  ds_read_b64_tr_b16 v[70:71], v53 offset:0
  ds_read_b64_tr_b16 v[72:73], v53 offset:4096
  ds_read_b64_tr_b16 v[74:75], v54 offset:0
  ds_read_b64_tr_b16 v[76:77], v54 offset:4096
  ds_read_b64_tr_b16 v[78:79], v55 offset:0
  ds_read_b64_tr_b16 v[80:81], v55 offset:4096
  ds_read_b64_tr_b16 v[82:83], v56 offset:0
  ds_read_b64_tr_b16 v[84:85], v56 offset:4096
  ds_read_b64_tr_b16 v[86:87], v57 offset:0
  ds_read_b64_tr_b16 v[88:89], v57 offset:4096
  s_add_u32 s60, s60, 1
  v_mov_b32 v4, s60
  s_waitcnt lgkmcnt(0)
  ds_write_b32 v22, v4
  s_add_u32 s58, s58, 4
  s_add_u32 s59, s59, 32768
  s_cmp_ge_u32 s59, 147456
  s_cselect_b32 s52, 147456, 0
  s_sub_u32 s59, s59, s52
  s_lshr_b32 s52, 1, s3
  s_bitcmp0_b32 s52, 0
  s_cbranch_scc1 pg_75
  s_add_u32 s52, s63, s97
  v_add_u32 v5, s52, v16
  s_bfm_b64 exec, 1, 0
  buffer_store_dword v5, v7, s[28:31], s50 offen sc0
  s_mov_b64 exec, -1
  s_branch pgx_76
pg_75:
  s_cmp_lg_u32 s3, 2
  s_cbranch_scc1 pgx_76
  s_waitcnt vmcnt(0)
  v_sub_u32 v5, v248, v16
  s_bfm_b64 exec, 32, 0
  buffer_load_dword v248, v246, s[28:31], s48 offen sc1
  s_mov_b64 exec, -1
  v_readlane_b32 s52, v5, s55
  s_bfm_b64 exec, 32, 0
  v_cmp_gt_u32 vcc, 0x200, v5
  s_mov_b64 exec, -1
  v_subrev_u32 v5, s52, v5
  s_bcnt1_i32_b64 s61, vcc
  s_cmp_ge_u32 s52, 0x200
  s_cbranch_scc1 pgx_76
  v_cndmask_b32 v5, v7, v5, vcc
  s_nop 1
  v_add_u32_dpp v5, v5, v5 row_ror:8 row_mask:0xf bank_mask:0xf
  s_nop 1
  v_add_u32_dpp v5, v5, v5 row_ror:4 row_mask:0xf bank_mask:0xf
  s_nop 1
  v_add_u32_dpp v5, v5, v5 row_ror:2 row_mask:0xf bank_mask:0xf
  s_nop 1
  v_add_u32_dpp v5, v5, v5 row_ror:1 row_mask:0xf bank_mask:0xf
  s_nop 1
  v_add_u32_dpp v5, v5, v5 row_bcast:15 row_mask:0xa bank_mask:0xf
  s_nop 1
  v_add_u32_dpp v5, v5, v5 row_bcast:31 row_mask:0xc bank_mask:0xf
  s_nop 0
  v_readlane_b32 s96, v5, 63
  s_mov_b32 s53, 3
  s_lshl_b32 s96, s96, 6
  s_mul_i32 s52, s61, 44
  s_cmp_gt_i32 s96, s52
  s_cselect_b32 s53, 4, s53
  s_sub_i32 s52, 0, s52
  s_cmp_lt_i32 s96, s52
  s_cselect_b32 s53, 2, s53
  s_mul_i32 s52, s61, 128
  s_cmp_gt_i32 s96, s52
  s_cselect_b32 s53, 5, s53
  s_sub_i32 s52, 0, s52
  s_cmp_lt_i32 s96, s52
  s_cselect_b32 s53, 1, s53
  v_mov_b32 v5, s53
  s_mov_b64 exec, 1
  ds_write_b32 v45, v5 offset:32
  s_mov_b64 exec, -1
pgx_76:
  v_and_b32 v6, 31, v1
  v_lshlrev_b32 v6, 4, v6
  s_lshl_b32 s53, s57, 9
  s_add_u32 s53, s53, 262144
ml_66:
  buffer_load_dwordx4 v[12:15], v6, s[28:31], s53 offen sc0 sc1
  s_waitcnt vmcnt(0)
  v_xor_b32 v13, v13, v16
  v_xor_b32 v15, v15, v16
  v_or_b32 v13, v13, v15
  v_cmp_ne_u32 vcc, 0, v13
  s_cbranch_vccz mld_67
  s_mov_b64 exec, vcc
  s_sub_u32 s62, s62, 1
  s_cbranch_scc1 L_end
  s_branch ml_66
mld_67:
  s_mov_b64 exec, -1
  v_mov_b32 v47, v12
  s_nop 1
  v_max_f32_dpp v47, v47, v47 row_ror:8 row_mask:0xf bank_mask:0xf
  s_nop 1
  v_max_f32_dpp v47, v47, v47 row_ror:4 row_mask:0xf bank_mask:0xf
  s_nop 1
  v_max_f32_dpp v47, v47, v47 row_ror:2 row_mask:0xf bank_mask:0xf
  v_mov_b32 v4, v47
  s_nop 1
  v_permlane16_swap_b32 v4, v47
  v_max_f32 v47, v47, v4
  v_mov_b32 v4, v47
  s_nop 1
  v_permlane32_swap_b32 v4, v47
  v_max_f32 v47, v47, v4
  v_sub_f32 v12, v12, v47
  v_mul_f32 v12, 0x3fb8aa3b, v12
  v_exp_f32 v12, v12
  v_mul_f32 v13, 0.5, v14
  v_mul_f32 v9, v13, v12
  s_nop 1
  v_add_f32_dpp v9, v9, v9 row_ror:8 row_mask:0xf bank_mask:0xf
  s_nop 1
  v_add_f32_dpp v9, v9, v9 row_ror:4 row_mask:0xf bank_mask:0xf
  s_nop 1
  v_add_f32_dpp v9, v9, v9 row_ror:2 row_mask:0xf bank_mask:0xf
  v_mov_b32 v4, v9
  s_nop 1
  v_permlane16_swap_b32 v4, v9
  v_add_f32 v9, v9, v4
  v_mov_b32 v4, v9
  s_nop 1
  v_permlane32_swap_b32 v4, v9
  v_add_f32 v9, v9, v4
  v_rcp_f32 v10, v9
  s_nop 0
  v_fma_f32 v11, -v9, v10, 1.0
  v_fma_f32 v48, v11, v10, v10
  s_mov_b32 s46, 0x00030003
  s_mov_b32 s47, 0x00030003
  v_and_b32 v8, 1, v3
  v_lshlrev_b32 v8, 9, v8
  v_lshrrev_b32 v9, 1, v3
  v_lshl_add_u32 v8, v9, 6, v8
  v_lshl_add_u32 v38, v2, 4, v8
  v_add_u32 v8, 152832, v38
  s_xor_b32 s52, s3, 0
  s_lshl_b32 s52, s52, 10
  v_add_u32 v34, s52, v8
  s_xor_b32 s52, s3, 1
  s_lshl_b32 s52, s52, 10
  v_add_u32 v35, s52, v8
  s_xor_b32 s52, s3, 2
  s_lshl_b32 s52, s52, 10
  v_add_u32 v36, s52, v8
  s_xor_b32 s52, s3, 3
  s_lshl_b32 s52, s52, 10
  v_add_u32 v37, s52, v8
  v_sub_f32 v98, v106, v47
  v_sub_f32 v99, v107, v47
  v_sub_f32 v100, v108, v47
  v_sub_f32 v101, v109, v47
  v_sub_f32 v102, v110, v47
  v_sub_f32 v103, v111, v47
  v_sub_f32 v104, v112, v47
  v_sub_f32 v105, v113, v47
  v_mul_f32 v98, 0x3fb8aa3b, v98
  v_mul_f32 v99, 0x3fb8aa3b, v99
  v_mul_f32 v100, 0x3fb8aa3b, v100
  v_mul_f32 v101, 0x3fb8aa3b, v101
  v_mul_f32 v102, 0x3fb8aa3b, v102
  v_mul_f32 v103, 0x3fb8aa3b, v103
  v_mul_f32 v104, 0x3fb8aa3b, v104
  v_mul_f32 v105, 0x3fb8aa3b, v105
  v_exp_f32 v98, v98
  v_exp_f32 v99, v99
  v_exp_f32 v100, v100
  v_exp_f32 v101, v101
  v_exp_f32 v102, v102
  v_exp_f32 v103, v103
  v_exp_f32 v104, v104
  v_exp_f32 v105, v105
  v_mul_f32 v98, v98, v48
  v_mul_f32 v99, v99, v48
  v_mul_f32 v100, v100, v48
  v_mul_f32 v101, v101, v48
  v_mul_f32 v102, v102, v48
  v_mul_f32 v103, v103, v48
  v_mul_f32 v104, v104, v48
  v_mul_f32 v105, v105, v48
  v_cvt_pk_bf16_f32 v138, v98, v99
  v_cvt_pk_bf16_f32 v139, v100, v101
  v_cvt_pk_bf16_f32 v140, v102, v103
  v_cvt_pk_bf16_f32 v141, v104, v105
  v_mov_b32 v106, v114
  v_mov_b32 v107, v115
  v_mov_b32 v108, v116
  v_mov_b32 v109, v117
  v_mov_b32 v110, v118
  v_mov_b32 v111, v119
  v_mov_b32 v112, v120
  v_mov_b32 v113, v121
  v_mov_b32 v114, v122
  v_mov_b32 v115, v123
  v_mov_b32 v116, v124
  v_mov_b32 v117, v125
  v_mov_b32 v118, v126
  v_mov_b32 v119, v127
  v_mov_b32 v120, v128
  v_mov_b32 v121, v129
  v_mov_b32 v122, v130
  v_mov_b32 v123, v131
  v_mov_b32 v124, v132
  v_mov_b32 v125, v133
  v_mov_b32 v126, v134
  v_mov_b32 v127, v135
  v_mov_b32 v128, v136
  v_mov_b32 v129, v137
  v_cndmask_b32 v146, v7, v138, s[46:47]
  v_cndmask_b32 v147, v7, v139, s[46:47]
  v_cndmask_b32 v148, v7, v140, s[46:47]
  v_cndmask_b32 v149, v7, v141, s[46:47]
  v_mov_b32_dpp v150, v146 row_shr:2 row_mask:0xf bank_mask:0xf bound_ctrl:0
  v_mov_b32_dpp v151, v147 row_shr:2 row_mask:0xf bank_mask:0xf bound_ctrl:0
  v_mov_b32_dpp v152, v148 row_shr:2 row_mask:0xf bank_mask:0xf bound_ctrl:0
  v_mov_b32_dpp v153, v149 row_shr:2 row_mask:0xf bank_mask:0xf bound_ctrl:0
  v_mov_b32_dpp v154, v146 row_shr:4 row_mask:0xf bank_mask:0xf bound_ctrl:0
  v_mov_b32_dpp v155, v147 row_shr:4 row_mask:0xf bank_mask:0xf bound_ctrl:0
  v_mov_b32_dpp v156, v148 row_shr:4 row_mask:0xf bank_mask:0xf bound_ctrl:0
  v_mov_b32_dpp v157, v149 row_shr:4 row_mask:0xf bank_mask:0xf bound_ctrl:0
  v_mov_b32_dpp v158, v146 row_shr:6 row_mask:0xf bank_mask:0xf bound_ctrl:0
  v_mov_b32_dpp v159, v147 row_shr:6 row_mask:0xf bank_mask:0xf bound_ctrl:0
  v_mov_b32_dpp v160, v148 row_shr:6 row_mask:0xf bank_mask:0xf bound_ctrl:0
  v_mov_b32_dpp v161, v149 row_shr:6 row_mask:0xf bank_mask:0xf bound_ctrl:0
  v_mov_b32_dpp v162, v146 row_shr:8 row_mask:0xf bank_mask:0xf bound_ctrl:0
  v_mov_b32_dpp v163, v147 row_shr:8 row_mask:0xf bank_mask:0xf bound_ctrl:0
  v_mov_b32_dpp v164, v148 row_shr:8 row_mask:0xf bank_mask:0xf bound_ctrl:0
  v_mov_b32_dpp v165, v149 row_shr:8 row_mask:0xf bank_mask:0xf bound_ctrl:0
  v_mov_b32_dpp v166, v146 row_shr:10 row_mask:0xf bank_mask:0xf bound_ctrl:0
  v_mov_b32_dpp v167, v147 row_shr:10 row_mask:0xf bank_mask:0xf bound_ctrl:0
  v_mov_b32_dpp v168, v148 row_shr:10 row_mask:0xf bank_mask:0xf bound_ctrl:0
  v_mov_b32_dpp v169, v149 row_shr:10 row_mask:0xf bank_mask:0xf bound_ctrl:0
  v_mov_b32_dpp v170, v146 row_shr:12 row_mask:0xf bank_mask:0xf bound_ctrl:0
  v_mov_b32_dpp v171, v147 row_shr:12 row_mask:0xf bank_mask:0xf bound_ctrl:0
  v_mov_b32_dpp v172, v148 row_shr:12 row_mask:0xf bank_mask:0xf bound_ctrl:0
  v_mov_b32_dpp v173, v149 row_shr:12 row_mask:0xf bank_mask:0xf bound_ctrl:0
  v_mov_b32_dpp v174, v146 row_shr:14 row_mask:0xf bank_mask:0xf bound_ctrl:0
  v_mov_b32_dpp v175, v147 row_shr:14 row_mask:0xf bank_mask:0xf bound_ctrl:0
  v_mov_b32_dpp v176, v148 row_shr:14 row_mask:0xf bank_mask:0xf bound_ctrl:0
  v_mov_b32_dpp v177, v149 row_shr:14 row_mask:0xf bank_mask:0xf bound_ctrl:0
  v_mfma_f32_16x16x32_bf16 v[142:145], v[210:213], v[146:149], v[142:145]
  v_mfma_f32_16x16x32_bf16 v[142:145], v[214:217], v[150:153], v[142:145]
  v_mfma_f32_16x16x32_bf16 v[142:145], v[218:221], v[154:157], v[142:145]
  v_mfma_f32_16x16x32_bf16 v[142:145], v[222:225], v[158:161], v[142:145]
  v_mfma_f32_16x16x32_bf16 v[142:145], v[226:229], v[162:165], v[142:145]
  v_mfma_f32_16x16x32_bf16 v[142:145], v[230:233], v[166:169], v[142:145]
  v_mfma_f32_16x16x32_bf16 v[142:145], v[234:237], v[170:173], v[142:145]
  v_mfma_f32_16x16x32_bf16 v[142:145], v[238:241], v[174:177], v[142:145]
  v_mov_b32_dpp v138, v138 row_shl:2 row_mask:0xf bank_mask:0xf
  v_mov_b32_dpp v139, v139 row_shl:2 row_mask:0xf bank_mask:0xf
  v_mov_b32_dpp v140, v140 row_shl:2 row_mask:0xf bank_mask:0xf
  v_mov_b32_dpp v141, v141 row_shl:2 row_mask:0xf bank_mask:0xf
  v_cndmask_b32 v146, v7, v138, s[46:47]
  v_cndmask_b32 v147, v7, v139, s[46:47]
  v_cndmask_b32 v148, v7, v140, s[46:47]
  v_cndmask_b32 v149, v7, v141, s[46:47]
  v_mov_b32_dpp v150, v146 row_shr:2 row_mask:0xf bank_mask:0xf bound_ctrl:0
  v_mov_b32_dpp v151, v147 row_shr:2 row_mask:0xf bank_mask:0xf bound_ctrl:0
  v_mov_b32_dpp v152, v148 row_shr:2 row_mask:0xf bank_mask:0xf bound_ctrl:0
  v_mov_b32_dpp v153, v149 row_shr:2 row_mask:0xf bank_mask:0xf bound_ctrl:0
  v_mov_b32_dpp v154, v146 row_shr:4 row_mask:0xf bank_mask:0xf bound_ctrl:0
  v_mov_b32_dpp v155, v147 row_shr:4 row_mask:0xf bank_mask:0xf bound_ctrl:0
  v_mov_b32_dpp v156, v148 row_shr:4 row_mask:0xf bank_mask:0xf bound_ctrl:0
  v_mov_b32_dpp v157, v149 row_shr:4 row_mask:0xf bank_mask:0xf bound_ctrl:0
  v_mov_b32_dpp v158, v146 row_shr:6 row_mask:0xf bank_mask:0xf bound_ctrl:0
  v_mov_b32_dpp v159, v147 row_shr:6 row_mask:0xf bank_mask:0xf bound_ctrl:0
  v_mov_b32_dpp v160, v148 row_shr:6 row_mask:0xf bank_mask:0xf bound_ctrl:0
  v_mov_b32_dpp v161, v149 row_shr:6 row_mask:0xf bank_mask:0xf bound_ctrl:0
  v_mov_b32_dpp v162, v146 row_shr:8 row_mask:0xf bank_mask:0xf bound_ctrl:0
  v_mov_b32_dpp v163, v147 row_shr:8 row_mask:0xf bank_mask:0xf bound_ctrl:0
  v_mov_b32_dpp v164, v148 row_shr:8 row_mask:0xf bank_mask:0xf bound_ctrl:0
  v_mov_b32_dpp v165, v149 row_shr:8 row_mask:0xf bank_mask:0xf bound_ctrl:0
  v_mov_b32_dpp v166, v146 row_shr:10 row_mask:0xf bank_mask:0xf bound_ctrl:0
  v_mov_b32_dpp v167, v147 row_shr:10 row_mask:0xf bank_mask:0xf bound_ctrl:0
  v_mov_b32_dpp v168, v148 row_shr:10 row_mask:0xf bank_mask:0xf bound_ctrl:0
  v_mov_b32_dpp v169, v149 row_shr:10 row_mask:0xf bank_mask:0xf bound_ctrl:0
  v_mov_b32_dpp v170, v146 row_shr:12 row_mask:0xf bank_mask:0xf bound_ctrl:0
  v_mov_b32_dpp v171, v147 row_shr:12 row_mask:0xf bank_mask:0xf bound_ctrl:0
  v_mov_b32_dpp v172, v148 row_shr:12 row_mask:0xf bank_mask:0xf bound_ctrl:0
  v_mov_b32_dpp v173, v149 row_shr:12 row_mask:0xf bank_mask:0xf bound_ctrl:0
  v_mov_b32_dpp v174, v146 row_shr:14 row_mask:0xf bank_mask:0xf bound_ctrl:0
  v_mov_b32_dpp v175, v147 row_shr:14 row_mask:0xf bank_mask:0xf bound_ctrl:0
  v_mov_b32_dpp v176, v148 row_shr:14 row_mask:0xf bank_mask:0xf bound_ctrl:0
  v_mov_b32_dpp v177, v149 row_shr:14 row_mask:0xf bank_mask:0xf bound_ctrl:0
  v_mfma_f32_16x16x32_bf16 v[142:145], v[58:61], v[146:149], v[142:145]
  v_mfma_f32_16x16x32_bf16 v[142:145], v[62:65], v[150:153], v[142:145]
  v_mfma_f32_16x16x32_bf16 v[142:145], v[66:69], v[154:157], v[142:145]
  v_mfma_f32_16x16x32_bf16 v[142:145], v[70:73], v[158:161], v[142:145]
  v_mfma_f32_16x16x32_bf16 v[142:145], v[74:77], v[162:165], v[142:145]
  v_mfma_f32_16x16x32_bf16 v[142:145], v[78:81], v[166:169], v[142:145]
  v_mfma_f32_16x16x32_bf16 v[142:145], v[82:85], v[170:173], v[142:145]
  v_mfma_f32_16x16x32_bf16 v[142:145], v[86:89], v[174:177], v[142:145]
  v_mov_b32_dpp v138, v138 row_shl:2 row_mask:0xf bank_mask:0xf
  v_mov_b32_dpp v139, v139 row_shl:2 row_mask:0xf bank_mask:0xf
  v_mov_b32_dpp v140, v140 row_shl:2 row_mask:0xf bank_mask:0xf
  v_mov_b32_dpp v141, v141 row_shl:2 row_mask:0xf bank_mask:0xf
  s_branch vl_78
vg_77:
  s_cmp_lg_u32 s60, 48
  s_cbranch_scc1 rdyx_83
  s_cmp_lg_u32 s3, 1
  s_cbranch_scc1 rdyy_84
  v_lshlrev_b32 v4, 5, v1
  s_mov_b32 s52, 262144
  s_mov_b32 s53, 266240
rdy_81:
  buffer_load_dword v12, v4, s[28:31], s52 offen offset:4 sc0 sc1
  buffer_load_dword v13, v4, s[28:31], s52 offen offset:2052 sc0 sc1
  buffer_load_dword v14, v4, s[28:31], s53 offen offset:4 sc0 sc1
  buffer_load_dword v15, v4, s[28:31], s53 offen offset:2052 sc0 sc1
  s_waitcnt vmcnt(0)
  v_xor_b32 v12, v12, v16
  v_xor_b32 v13, v13, v16
  v_xor_b32 v14, v14, v16
  v_xor_b32 v15, v15, v16
  v_or3_b32 v12, v12, v13, v14
  v_or_b32 v12, v12, v15
  v_cmp_ne_u32 vcc, 0, v12
  s_cbranch_vccz rdyd_82
  s_sub_u32 s62, s62, 1
  s_cbranch_scc1 L_end
  s_branch rdy_81
rdyd_82:
  s_mov_b64 exec, 1
  ds_write_b32 v45, v46 offset:36
  s_mov_b64 exec, -1
  s_cmp_lg_u32 s2, 0
  s_cbranch_scc1 rdyy_84
  v_subrev_u32 v12, 0x9e3769b9, v16
  s_mov_b64 exec, 1
  buffer_store_dword v12, v7, s[28:31], 0 offen offset:0 sc0 sc1
  s_mov_b64 exec, -1
  s_branch rdyy_84
rdyx_83:
  s_cmp_lg_u32 s60, 56
  s_cbranch_scc1 rdyy_84
spin_85:
  ds_read_b32 v5, v45 offset:36
  s_waitcnt lgkmcnt(0)
  v_readfirstlane_b32 s52, v5
  s_nop 0
  s_cmp_ge_i32 s52, 1
  s_cbranch_scc1 done_86
  s_sub_u32 s62, s62, 1
  s_cbranch_scc1 L_end
  s_sleep 1
  s_branch spin_85
done_86:
rdyy_84:
  v_sub_f32 v98, v106, v47
  v_sub_f32 v99, v107, v47
  v_sub_f32 v100, v108, v47
  v_sub_f32 v101, v109, v47
  v_sub_f32 v102, v110, v47
  v_sub_f32 v103, v111, v47
  v_sub_f32 v104, v112, v47
  v_sub_f32 v105, v113, v47
  v_mul_f32 v98, 0x3fb8aa3b, v98
  v_mul_f32 v99, 0x3fb8aa3b, v99
  v_mul_f32 v100, 0x3fb8aa3b, v100
  v_mul_f32 v101, 0x3fb8aa3b, v101
  v_mul_f32 v102, 0x3fb8aa3b, v102
  v_mul_f32 v103, 0x3fb8aa3b, v103
  v_mul_f32 v104, 0x3fb8aa3b, v104
  v_mul_f32 v105, 0x3fb8aa3b, v105
  v_exp_f32 v98, v98
  v_exp_f32 v99, v99
  v_exp_f32 v100, v100
  v_exp_f32 v101, v101
  v_exp_f32 v102, v102
  v_exp_f32 v103, v103
  v_exp_f32 v104, v104
  v_exp_f32 v105, v105
  v_mul_f32 v98, v98, v48
  v_mul_f32 v99, v99, v48
  v_mul_f32 v100, v100, v48
  v_mul_f32 v101, v101, v48
  v_mul_f32 v102, v102, v48
  v_mul_f32 v103, v103, v48
  v_mul_f32 v104, v104, v48
  v_mul_f32 v105, v105, v48
  v_cvt_pk_bf16_f32 v138, v98, v99
  v_cvt_pk_bf16_f32 v139, v100, v101
  v_cvt_pk_bf16_f32 v140, v102, v103
  v_cvt_pk_bf16_f32 v141, v104, v105
  v_mov_b32 v106, v114
  v_mov_b32 v107, v115
  v_mov_b32 v108, v116
  v_mov_b32 v109, v117
  v_mov_b32 v110, v118
  v_mov_b32 v111, v119
  v_mov_b32 v112, v120
  v_mov_b32 v113, v121
  v_mov_b32 v114, v122
  v_mov_b32 v115, v123
  v_mov_b32 v116, v124
  v_mov_b32 v117, v125
  v_mov_b32 v118, v126
  v_mov_b32 v119, v127
  v_mov_b32 v120, v128
  v_mov_b32 v121, v129
  v_mov_b32 v122, v130
  v_mov_b32 v123, v131
  v_mov_b32 v124, v132
  v_mov_b32 v125, v133
  v_mov_b32 v126, v134
  v_mov_b32 v127, v135
  v_mov_b32 v128, v136
  v_mov_b32 v129, v137
vl_78:
  v_cndmask_b32 v146, v7, v138, s[46:47]
  v_cndmask_b32 v147, v7, v139, s[46:47]
  v_cndmask_b32 v148, v7, v140, s[46:47]
  v_cndmask_b32 v149, v7, v141, s[46:47]
  v_mov_b32_dpp v150, v146 row_shr:2 row_mask:0xf bank_mask:0xf bound_ctrl:0
  v_mov_b32_dpp v151, v147 row_shr:2 row_mask:0xf bank_mask:0xf bound_ctrl:0
  v_mov_b32_dpp v152, v148 row_shr:2 row_mask:0xf bank_mask:0xf bound_ctrl:0
  v_mov_b32_dpp v153, v149 row_shr:2 row_mask:0xf bank_mask:0xf bound_ctrl:0
  v_mov_b32_dpp v154, v146 row_shr:4 row_mask:0xf bank_mask:0xf bound_ctrl:0
  v_mov_b32_dpp v155, v147 row_shr:4 row_mask:0xf bank_mask:0xf bound_ctrl:0
  v_mov_b32_dpp v156, v148 row_shr:4 row_mask:0xf bank_mask:0xf bound_ctrl:0
  v_mov_b32_dpp v157, v149 row_shr:4 row_mask:0xf bank_mask:0xf bound_ctrl:0
  v_mov_b32_dpp v158, v146 row_shr:6 row_mask:0xf bank_mask:0xf bound_ctrl:0
  v_mov_b32_dpp v159, v147 row_shr:6 row_mask:0xf bank_mask:0xf bound_ctrl:0
  v_mov_b32_dpp v160, v148 row_shr:6 row_mask:0xf bank_mask:0xf bound_ctrl:0
  v_mov_b32_dpp v161, v149 row_shr:6 row_mask:0xf bank_mask:0xf bound_ctrl:0
  v_mov_b32_dpp v162, v146 row_shr:8 row_mask:0xf bank_mask:0xf bound_ctrl:0
  v_mov_b32_dpp v163, v147 row_shr:8 row_mask:0xf bank_mask:0xf bound_ctrl:0
  v_mov_b32_dpp v164, v148 row_shr:8 row_mask:0xf bank_mask:0xf bound_ctrl:0
  v_mov_b32_dpp v165, v149 row_shr:8 row_mask:0xf bank_mask:0xf bound_ctrl:0
  v_mov_b32_dpp v166, v146 row_shr:10 row_mask:0xf bank_mask:0xf bound_ctrl:0
  v_mov_b32_dpp v167, v147 row_shr:10 row_mask:0xf bank_mask:0xf bound_ctrl:0
  v_mov_b32_dpp v168, v148 row_shr:10 row_mask:0xf bank_mask:0xf bound_ctrl:0
  v_mov_b32_dpp v169, v149 row_shr:10 row_mask:0xf bank_mask:0xf bound_ctrl:0
  v_mov_b32_dpp v170, v146 row_shr:12 row_mask:0xf bank_mask:0xf bound_ctrl:0
  v_mov_b32_dpp v171, v147 row_shr:12 row_mask:0xf bank_mask:0xf bound_ctrl:0
  v_mov_b32_dpp v172, v148 row_shr:12 row_mask:0xf bank_mask:0xf bound_ctrl:0
  v_mov_b32_dpp v173, v149 row_shr:12 row_mask:0xf bank_mask:0xf bound_ctrl:0
  v_mov_b32_dpp v174, v146 row_shr:14 row_mask:0xf bank_mask:0xf bound_ctrl:0
  v_mov_b32_dpp v175, v147 row_shr:14 row_mask:0xf bank_mask:0xf bound_ctrl:0
  v_mov_b32_dpp v176, v148 row_shr:14 row_mask:0xf bank_mask:0xf bound_ctrl:0
  v_mov_b32_dpp v177, v149 row_shr:14 row_mask:0xf bank_mask:0xf bound_ctrl:0
  v_add_u32 v50, s59, v44
  v_xor_b32 v51, 0x20, v50
  v_xor_b32 v52, 0x40, v50
  v_xor_b32 v53, 0x60, v50
  v_xor_b32 v54, 0x80, v50
  v_xor_b32 v55, 0xa0, v50
  v_xor_b32 v56, 0xc0, v50
  v_xor_b32 v57, 0xe0, v50
  s_cmp_eq_u32 s60, 63
  s_cbranch_scc1 ve_79
  s_add_u32 s61, s58, 1
spin_87:
  ds_read_b32 v4, v21 offset:0
  s_waitcnt lgkmcnt(0)
  v_readfirstlane_b32 s52, v4
  s_nop 0
  s_cmp_ge_i32 s52, s61
  s_cbranch_scc1 done_88
  s_sub_u32 s62, s62, 1
  s_cbranch_scc1 L_end
  s_branch spin_87
done_88:
  s_mov_b32 s63, s52
  ds_read_b64_tr_b16 v[58:59], v50 offset:0
  ds_read_b64_tr_b16 v[60:61], v50 offset:4096
  ds_read_b64_tr_b16 v[62:63], v51 offset:0
  ds_read_b64_tr_b16 v[64:65], v51 offset:4096
  ds_read_b64_tr_b16 v[66:67], v52 offset:0
  ds_read_b64_tr_b16 v[68:69], v52 offset:4096
  ds_read_b64_tr_b16 v[70:71], v53 offset:0
  ds_read_b64_tr_b16 v[72:73], v53 offset:4096
  ds_read_b64_tr_b16 v[74:75], v54 offset:0
  ds_read_b64_tr_b16 v[76:77], v54 offset:4096
  ds_read_b64_tr_b16 v[78:79], v55 offset:0
  ds_read_b64_tr_b16 v[80:81], v55 offset:4096
  ds_read_b64_tr_b16 v[82:83], v56 offset:0
  ds_read_b64_tr_b16 v[84:85], v56 offset:4096
  ds_read_b64_tr_b16 v[86:87], v57 offset:0
  ds_read_b64_tr_b16 v[88:89], v57 offset:4096
  s_add_u32 s60, s60, 1
  v_mov_b32 v4, s60
  s_waitcnt lgkmcnt(14)
  v_mfma_f32_16x16x32_bf16 v[142:145], v[58:61], v[146:149], v[142:145]
  s_waitcnt lgkmcnt(12)
  v_mfma_f32_16x16x32_bf16 v[142:145], v[62:65], v[150:153], v[142:145]
  s_waitcnt lgkmcnt(10)
  v_mfma_f32_16x16x32_bf16 v[142:145], v[66:69], v[154:157], v[142:145]
  s_waitcnt lgkmcnt(8)
  v_mfma_f32_16x16x32_bf16 v[142:145], v[70:73], v[158:161], v[142:145]
  s_waitcnt lgkmcnt(6)
  v_mfma_f32_16x16x32_bf16 v[142:145], v[74:77], v[162:165], v[142:145]
  s_waitcnt lgkmcnt(4)
  v_mfma_f32_16x16x32_bf16 v[142:145], v[78:81], v[166:169], v[142:145]
  s_waitcnt lgkmcnt(2)
  v_mfma_f32_16x16x32_bf16 v[142:145], v[82:85], v[170:173], v[142:145]
  s_waitcnt lgkmcnt(0)
  v_mfma_f32_16x16x32_bf16 v[142:145], v[86:89], v[174:177], v[142:145]
  ds_write_b32 v22, v4
  s_add_u32 s58, s58, 4
  s_add_u32 s59, s59, 32768
  s_cmp_ge_u32 s59, 147456
  s_cselect_b32 s52, 147456, 0
  s_sub_u32 s59, s59, s52
  v_mov_b32_dpp v138, v138 row_shl:2 row_mask:0xf bank_mask:0xf
  v_mov_b32_dpp v139, v139 row_shl:2 row_mask:0xf bank_mask:0xf
  v_mov_b32_dpp v140, v140 row_shl:2 row_mask:0xf bank_mask:0xf
  v_mov_b32_dpp v141, v141 row_shl:2 row_mask:0xf bank_mask:0xf
  s_lshr_b32 s52, 1, s3
  s_bitcmp0_b32 s52, 0
  s_cbranch_scc1 pg_89
  s_add_u32 s52, s63, s97
  v_add_u32 v5, s52, v16
  s_bfm_b64 exec, 1, 0
  buffer_store_dword v5, v7, s[28:31], s50 offen sc0
  s_mov_b64 exec, -1
  s_branch pgx_90
pg_89:
  s_cmp_lg_u32 s3, 2
  s_cbranch_scc1 pgx_90
  s_waitcnt vmcnt(0)
  v_sub_u32 v5, v248, v16
  s_bfm_b64 exec, 32, 0
  buffer_load_dword v248, v246, s[28:31], s48 offen sc1
  s_mov_b64 exec, -1
  v_readlane_b32 s52, v5, s55
  s_bfm_b64 exec, 32, 0
  v_cmp_gt_u32 vcc, 0x200, v5
  s_mov_b64 exec, -1
  v_subrev_u32 v5, s52, v5
  s_bcnt1_i32_b64 s61, vcc
  s_cmp_ge_u32 s52, 0x200
  s_cbranch_scc1 pgx_90
  v_cndmask_b32 v5, v7, v5, vcc
  s_nop 1
  v_add_u32_dpp v5, v5, v5 row_ror:8 row_mask:0xf bank_mask:0xf
  s_nop 1
  v_add_u32_dpp v5, v5, v5 row_ror:4 row_mask:0xf bank_mask:0xf
  s_nop 1
  v_add_u32_dpp v5, v5, v5 row_ror:2 row_mask:0xf bank_mask:0xf
  s_nop 1
  v_add_u32_dpp v5, v5, v5 row_ror:1 row_mask:0xf bank_mask:0xf
  s_nop 1
  v_add_u32_dpp v5, v5, v5 row_bcast:15 row_mask:0xa bank_mask:0xf
  s_nop 1
  v_add_u32_dpp v5, v5, v5 row_bcast:31 row_mask:0xc bank_mask:0xf
  s_nop 0
  v_readlane_b32 s96, v5, 63
  s_mov_b32 s53, 3
  s_lshl_b32 s96, s96, 6
  s_mul_i32 s52, s61, 44
  s_cmp_gt_i32 s96, s52
  s_cselect_b32 s53, 4, s53
  s_sub_i32 s52, 0, s52
  s_cmp_lt_i32 s96, s52
  s_cselect_b32 s53, 2, s53
  s_mul_i32 s52, s61, 128
  s_cmp_gt_i32 s96, s52
  s_cselect_b32 s53, 5, s53
  s_sub_i32 s52, 0, s52
  s_cmp_lt_i32 s96, s52
  s_cselect_b32 s53, 1, s53
  v_mov_b32 v5, s53
  s_mov_b64 exec, 1
  ds_write_b32 v45, v5 offset:32
  s_mov_b64 exec, -1
pgx_90:
ns_80:
  s_and_b32 s52, s60, 7
  s_cbranch_scc1 vl_78
  s_branch vg_77
ve_79:
  s_lshl_b32 s96, s1, 10
  s_add_u32 s96, s96, 327680
  s_add_u32 s61, s58, 1
spin_92:
  ds_read_b32 v4, v21 offset:0
  s_waitcnt lgkmcnt(0)
  v_readfirstlane_b32 s52, v4
  s_nop 0
  s_cmp_ge_i32 s52, s61
  s_cbranch_scc1 done_93
  s_sub_u32 s62, s62, 1
  s_cbranch_scc1 L_end
  s_branch spin_92
done_93:
  s_mov_b32 s63, s52
  ds_read_b64_tr_b16 v[58:59], v50 offset:0
  ds_read_b64_tr_b16 v[60:61], v50 offset:4096
  ds_read_b64_tr_b16 v[62:63], v51 offset:0
  ds_read_b64_tr_b16 v[64:65], v51 offset:4096
  ds_read_b64_tr_b16 v[66:67], v52 offset:0
  ds_read_b64_tr_b16 v[68:69], v52 offset:4096
  ds_read_b64_tr_b16 v[70:71], v53 offset:0
  ds_read_b64_tr_b16 v[72:73], v53 offset:4096
  ds_read_b64_tr_b16 v[74:75], v54 offset:0
  ds_read_b64_tr_b16 v[76:77], v54 offset:4096
  ds_read_b64_tr_b16 v[78:79], v55 offset:0
  ds_read_b64_tr_b16 v[80:81], v55 offset:4096
  ds_read_b64_tr_b16 v[82:83], v56 offset:0
  ds_read_b64_tr_b16 v[84:85], v56 offset:4096
  ds_read_b64_tr_b16 v[86:87], v57 offset:0
  ds_read_b64_tr_b16 v[88:89], v57 offset:4096
  s_add_u32 s60, s60, 1
  v_mov_b32 v4, s60
  s_waitcnt lgkmcnt(14)
  v_mfma_f32_16x16x32_bf16 v[142:145], v[58:61], v[146:149], v[142:145]
  s_waitcnt lgkmcnt(12)
  v_mfma_f32_16x16x32_bf16 v[142:145], v[62:65], v[150:153], v[142:145]
  s_waitcnt lgkmcnt(10)
  v_mfma_f32_16x16x32_bf16 v[142:145], v[66:69], v[154:157], v[142:145]
  s_waitcnt lgkmcnt(8)
  v_mfma_f32_16x16x32_bf16 v[142:145], v[70:73], v[158:161], v[142:145]
  s_waitcnt lgkmcnt(6)
  v_mfma_f32_16x16x32_bf16 v[142:145], v[74:77], v[162:165], v[142:145]
  s_waitcnt lgkmcnt(4)
  v_mfma_f32_16x16x32_bf16 v[142:145], v[78:81], v[166:169], v[142:145]
  s_waitcnt lgkmcnt(2)
  v_mfma_f32_16x16x32_bf16 v[142:145], v[82:85], v[170:173], v[142:145]
  s_waitcnt lgkmcnt(0)
  v_mfma_f32_16x16x32_bf16 v[142:145], v[86:89], v[174:177], v[142:145]
  ds_write_b32 v22, v4
  s_nop 6
  ds_write_b128 v34, v[142:145]
  s_mov_b64 exec, 1
  ds_add_rtn_u32 v5, v45, v46 offset:8
  s_mov_b64 exec, -1
  ds_read_b128 v[106:109], v35
  ds_read_b128 v[110:113], v36
  ds_read_b128 v[114:117], v37
  s_waitcnt lgkmcnt(3)
  v_readfirstlane_b32 s52, v5
  s_nop 0
  s_cmp_lg_u32 s52, 3
  s_waitcnt lgkmcnt(0)
  s_cbranch_scc1 ox_91
  v_pk_add_f32 v[110:111], v[110:111], v[114:115]
  v_pk_add_f32 v[112:113], v[112:113], v[116:117]
  v_pk_add_f32 v[106:107], v[106:107], v[142:143]
  v_pk_add_f32 v[108:109], v[108:109], v[144:145]
  v_pk_add_f32 v[12:13], v[106:107], v[110:111]
  v_pk_add_f32 v[14:15], v[108:109], v[112:113]
  v_min_u32 v12, -2, v12
  v_min_u32 v13, -2, v13
  v_min_u32 v14, -2, v14
  v_min_u32 v15, -2, v15
  buffer_store_dwordx4 v[12:15], v38, s[28:31], s96 offen sc0 sc1
  s_mov_b64 exec, 1
  ds_write_b32 v45, v46 offset:40
  s_mov_b64 exec, -1
ox_91:
  s_cmp_ge_u32 s2, 112
  s_cbranch_scc1 noO_94
  s_cmp_ge_u32 s2, 72
  s_cbranch_scc1 noF_95
  v_lshlrev_b32 v10, 12, v2
  v_lshl_add_u32 v10, v3, 4, v10
  s_lshl_b32 s58, s54, 15
  s_lshr_b32 s52, s3, 1
  s_lshl_b32 s52, s52, 14
  s_add_u32 s58, s58, s52
  s_and_b32 s52, s3, 1
  s_lshl_b32 s52, s52, 9
  s_add_u32 s58, s58, s52
  s_add_u32 s58, s58, 327680
  v_lshrrev_b32 v8, 2, v3
  v_lshl_add_u32 v8, v2, 3, v8
  v_lshlrev_b32 v8, 7, v8
  v_and_b32 v9, 3, v3
  v_lshl_add_u32 v8, v9, 3, v8
  v_lshrrev_b32 v9, 3, v3
  v_lshlrev_b32 v12, 1, v2
  v_and_b32 v12, 2, v12
  v_or_b32 v9, v9, v12
  v_xor_b32 v9, s3, v9
  v_lshl_add_u32 v8, v9, 5, v8
  v_add_u32 v8, 32768, v8
  s_lshl_b32 s52, s3, 8
  s_add_u32 s52, s52, 156928
  v_lshl_add_u32 v6, v17, 1, s52
  v_lshlrev_b32 v9, 4, v2
  v_add_u32 v11, 156928, v9
  v_mul_u32_u24 v12, 18432, v3
  v_add_u32 v9, v9, v12
  s_mov_b32 s50, 0x00ff00ff
  s_mov_b32 s51, 0x00ff00ff
  s_mul_i32 s59, s54, 2304
  s_lshl_b32 s53, s55, 8
  s_add_u32 s59, s59, s53
  s_lshl_b32 s53, s3, 6
  s_add_u32 s59, s59, s53
  s_add_u32 s59, s59, 589824
  s_getreg_b32 s60, hwreg(HW_REG_XCC_ID, 0, 3)
  s_lshl_b32 s60, s60, 10
  s_lshl_b32 s53, s2, 2
  s_add_u32 s60, s60, s53
  s_add_u32 s60, s60, 1277952
  s_movk_i32 s61, 257
spin_99:
  ds_read_b32 v4, v45 offset:44
  s_waitcnt lgkmcnt(0)
  v_readfirstlane_b32 s52, v4
  s_nop 0
  s_cmp_ge_i32 s52, 1
  s_cbranch_scc1 done_100
  s_sub_u32 s62, s62, 1
  s_cbranch_scc1 L_end
  s_branch spin_99
done_100:
  buffer_load_dwordx4 v[58:61], v10, s[28:31], s58 offen offset:0 sc0 sc1
  buffer_load_dwordx4 v[62:65], v10, s[28:31], s58 offen offset:1024 sc0 sc1
  buffer_load_dwordx4 v[66:69], v10, s[28:31], s58 offen offset:2048 sc0 sc1
  buffer_load_dwordx4 v[70:73], v10, s[28:31], s58 offen offset:3072 sc0 sc1
  buffer_load_dwordx4 v[74:77], v10, s[28:31], s58 offen offset:256 sc0 sc1
  buffer_load_dwordx4 v[78:81], v10, s[28:31], s58 offen offset:1280 sc0 sc1
  buffer_load_dwordx4 v[82:85], v10, s[28:31], s58 offen offset:2304 sc0 sc1
  buffer_load_dwordx4 v[86:89], v10, s[28:31], s58 offen offset:3328 sc0 sc1
spin_101:
  ds_read_b32 v4, v21 offset:0
  s_waitcnt lgkmcnt(0)
  v_readfirstlane_b32 s52, v4
  s_nop 0
  s_cmp_ge_i32 s52, s61
  s_cbranch_scc1 done_102
  s_sub_u32 s62, s62, 1
  s_cbranch_scc1 L_end
  s_branch spin_101
done_102:
  ds_read_b64_tr_b16 v[176:177], v8 offset:0
  ds_read_b64_tr_b16 v[178:179], v8 offset:512
  ds_read_b64_tr_b16 v[180:181], v8 offset:4096
  ds_read_b64_tr_b16 v[182:183], v8 offset:4608
  ds_read_b64_tr_b16 v[184:185], v8 offset:8192
  ds_read_b64_tr_b16 v[186:187], v8 offset:8704
  ds_read_b64_tr_b16 v[188:189], v8 offset:12288
  ds_read_b64_tr_b16 v[190:191], v8 offset:12800
  ds_read_b64_tr_b16 v[192:193], v8 offset:16384
  ds_read_b64_tr_b16 v[194:195], v8 offset:16896
  ds_read_b64_tr_b16 v[196:197], v8 offset:20480
  ds_read_b64_tr_b16 v[198:199], v8 offset:20992
  ds_read_b64_tr_b16 v[200:201], v8 offset:24576
  ds_read_b64_tr_b16 v[202:203], v8 offset:25088
  ds_read_b64_tr_b16 v[204:205], v8 offset:28672
  ds_read_b64_tr_b16 v[206:207], v8 offset:29184
  ds_read_b64_tr_b16 v[208:209], v8 offset:32768
  ds_read_b64_tr_b16 v[210:211], v8 offset:33280
  ds_read_b64_tr_b16 v[212:213], v8 offset:36864
  ds_read_b64_tr_b16 v[214:215], v8 offset:37376
  ds_read_b64_tr_b16 v[216:217], v8 offset:40960
  ds_read_b64_tr_b16 v[218:219], v8 offset:41472
  ds_read_b64_tr_b16 v[220:221], v8 offset:45056
  ds_read_b64_tr_b16 v[222:223], v8 offset:45568
  ds_read_b64_tr_b16 v[224:225], v8 offset:49152
  ds_read_b64_tr_b16 v[226:227], v8 offset:49664
  ds_read_b64_tr_b16 v[228:229], v8 offset:53248
  ds_read_b64_tr_b16 v[230:231], v8 offset:53760
  ds_read_b64_tr_b16 v[232:233], v8 offset:57344
  ds_read_b64_tr_b16 v[234:235], v8 offset:57856
  ds_read_b64_tr_b16 v[236:237], v8 offset:61440
  ds_read_b64_tr_b16 v[238:239], v8 offset:61952
  s_branch h1w_98
h1_96:
  buffer_load_dwordx4 v[58:61], v10, s[28:31], s58 offen offset:0 sc0 sc1
  buffer_load_dwordx4 v[62:65], v10, s[28:31], s58 offen offset:1024 sc0 sc1
  buffer_load_dwordx4 v[66:69], v10, s[28:31], s58 offen offset:2048 sc0 sc1
  buffer_load_dwordx4 v[70:73], v10, s[28:31], s58 offen offset:3072 sc0 sc1
  buffer_load_dwordx4 v[74:77], v10, s[28:31], s58 offen offset:256 sc0 sc1
  buffer_load_dwordx4 v[78:81], v10, s[28:31], s58 offen offset:1280 sc0 sc1
  buffer_load_dwordx4 v[82:85], v10, s[28:31], s58 offen offset:2304 sc0 sc1
  buffer_load_dwordx4 v[86:89], v10, s[28:31], s58 offen offset:3328 sc0 sc1
h1w_98:
  s_waitcnt vmcnt(4)
  v_pk_add_f32 v[90:91], v[58:59], v[62:63]
  v_pk_add_f32 v[92:93], v[60:61], v[64:65]
  v_pk_add_f32 v[90:91], v[90:91], v[66:67]
  v_pk_add_f32 v[92:93], v[92:93], v[68:69]
  v_pk_add_f32 v[90:91], v[90:91], v[70:71]
  v_pk_add_f32 v[92:93], v[92:93], v[72:73]
  s_waitcnt vmcnt(0)
  v_pk_add_f32 v[94:95], v[74:75], v[78:79]
  v_pk_add_f32 v[96:97], v[76:77], v[80:81]
  v_pk_add_f32 v[94:95], v[94:95], v[82:83]
  v_pk_add_f32 v[96:97], v[96:97], v[84:85]
  v_pk_add_f32 v[94:95], v[94:95], v[86:87]
  v_pk_add_f32 v[96:97], v[96:97], v[88:89]
  v_pk_add_f32 v[4:5], v[90:91], v[92:93]
  v_pk_add_f32 v[4:5], v[4:5], v[94:95]
  v_pk_add_f32 v[4:5], v[4:5], v[96:97]
  v_cmp_u_f32 vcc, v4, v5
  s_cbranch_vccz h1d_97
  s_mov_b64 exec, vcc
  s_sub_u32 s62, s62, 1
  s_cbranch_scc1 L_end
  s_and_b32 s52, s62, 63
  s_cbranch_scc1 h1_96
  v_max_u32 v4, v58, v59
  v_max3_u32 v4, v4, v60, v61
  v_max3_u32 v4, v4, v62, v63
  v_max3_u32 v4, v4, v64, v65
  v_max3_u32 v4, v4, v66, v67
  v_max3_u32 v4, v4, v68, v69
  v_max3_u32 v4, v4, v70, v71
  v_max3_u32 v4, v4, v72, v73
  v_max3_u32 v4, v4, v74, v75
  v_max3_u32 v4, v4, v76, v77
  v_max3_u32 v4, v4, v78, v79
  v_max3_u32 v4, v4, v80, v81
  v_max3_u32 v4, v4, v82, v83
  v_max3_u32 v4, v4, v84, v85
  v_max3_u32 v4, v4, v86, v87
  v_max3_u32 v4, v4, v88, v89
  v_cmp_eq_u32 vcc, -1, v4
  s_cbranch_vccz h1d_97
  s_mov_b64 exec, vcc
  s_sub_u32 s62, s62, 1
  s_cbranch_scc1 L_end
  s_branch h1_96
h1d_97:
  s_mov_b64 exec, -1
  v_permlane32_swap_b32 v90, v91
  v_permlane32_swap_b32 v92, v93
  v_permlane32_swap_b32 v94, v95
  v_permlane32_swap_b32 v96, v97
  v_add_f32 v90, v90, v91
  v_add_f32 v92, v92, v93
  v_add_f32 v94, v94, v95
  v_add_f32 v96, v96, v97
  v_permlane16_swap_b32 v90, v92
  s_nop 0
  v_permlane16_swap_b32 v94, v96
  v_add_f32 v90, v90, v92
  v_add_f32 v94, v94, v96
  v_cvt_pk_bf16_f32 v12, v90, v94
  ds_write_b16 v6, v12
  ds_write_b16_d16_hi v6, v12 offset:128
  s_mov_b64 exec, -1
  s_waitcnt lgkmcnt(0)
  s_barrier
  ds_read_b128 v[106:109], v11 offset:0
  ds_read_b128 v[110:113], v11 offset:64
  ds_read_b128 v[114:117], v11 offset:128
  ds_read_b128 v[118:121], v11 offset:192
  ds_read_b128 v[122:125], v11 offset:256
  ds_read_b128 v[126:129], v11 offset:320
  ds_read_b128 v[130:133], v11 offset:384
  ds_read_b128 v[134:137], v11 offset:448
  ds_read_b128 v[138:141], v11 offset:512
  ds_read_b128 v[142:145], v11 offset:576
  ds_read_b128 v[146:149], v11 offset:640
  ds_read_b128 v[150:153], v11 offset:704
  ds_read_b128 v[154:157], v11 offset:768
  ds_read_b128 v[158:161], v11 offset:832
  ds_read_b128 v[162:165], v11 offset:896
  ds_read_b128 v[166:169], v11 offset:960
  s_waitcnt lgkmcnt(15)
  v_mfma_f32_16x16x32_bf16 v[12:15], v[176:179], v[106:109], 0
  s_waitcnt lgkmcnt(14)
  v_mfma_f32_16x16x32_bf16 v[90:93], v[180:183], v[110:113], 0
  s_waitcnt lgkmcnt(13)
  v_mfma_f32_16x16x32_bf16 v[12:15], v[184:187], v[114:117], v[12:15]
  s_waitcnt lgkmcnt(12)
  v_mfma_f32_16x16x32_bf16 v[90:93], v[188:191], v[118:121], v[90:93]
  s_waitcnt lgkmcnt(11)
  v_mfma_f32_16x16x32_bf16 v[12:15], v[192:195], v[122:125], v[12:15]
  s_waitcnt lgkmcnt(10)
  v_mfma_f32_16x16x32_bf16 v[90:93], v[196:199], v[126:129], v[90:93]
  s_waitcnt lgkmcnt(9)
  v_mfma_f32_16x16x32_bf16 v[12:15], v[200:203], v[130:133], v[12:15]
  s_waitcnt lgkmcnt(8)
  v_mfma_f32_16x16x32_bf16 v[90:93], v[204:207], v[134:137], v[90:93]
  s_waitcnt lgkmcnt(7)
  v_mfma_f32_16x16x32_bf16 v[12:15], v[208:211], v[138:141], v[12:15]
  s_waitcnt lgkmcnt(6)
  v_mfma_f32_16x16x32_bf16 v[90:93], v[212:215], v[142:145], v[90:93]
  s_waitcnt lgkmcnt(5)
  v_mfma_f32_16x16x32_bf16 v[12:15], v[216:219], v[146:149], v[12:15]
  s_waitcnt lgkmcnt(4)
  v_mfma_f32_16x16x32_bf16 v[90:93], v[220:223], v[150:153], v[90:93]
  s_waitcnt lgkmcnt(3)
  v_mfma_f32_16x16x32_bf16 v[12:15], v[224:227], v[154:157], v[12:15]
  s_waitcnt lgkmcnt(2)
  v_mfma_f32_16x16x32_bf16 v[90:93], v[228:231], v[158:161], v[90:93]
  s_waitcnt lgkmcnt(1)
  v_mfma_f32_16x16x32_bf16 v[12:15], v[232:235], v[162:165], v[12:15]
  s_waitcnt lgkmcnt(0)
  v_mfma_f32_16x16x32_bf16 v[90:93], v[236:239], v[166:169], v[90:93]
  s_mov_b64 exec, s[50:51]
  s_nop 6
  v_pk_add_f32 v[12:13], v[12:13], v[90:91]
  v_pk_add_f32 v[14:15], v[14:15], v[92:93]
  v_min_u32 v12, -2, v12
  v_min_u32 v13, -2, v13
  v_min_u32 v14, -2, v14
  v_min_u32 v15, -2, v15
  buffer_store_dwordx4 v[12:15], v9, s[28:31], s59 offen sc0 sc1
  s_cmp_lg_u32 s3, 0
  s_cbranch_scc1 l2_103
  s_getreg_b32 s52, hwreg(HW_REG_XCC_ID, 0, 3)
  s_lshl_b32 s52, s52, 10
  s_lshl_b32 s53, s2, 2
  s_add_u32 s52, s52, s53
  s_add_u32 s52, s52, 1277952
  s_mov_b64 exec, 1
  buffer_store_dword v16, v7, s[28:31], s52 offen
  s_mov_b64 exec, -1
l2_103:
  s_lshl_b32 s52, s55, 2
  s_add_u32 s52, s52, s3
  s_mul_i32 s52, s52, 18432
  s_mul_i32 s53, s54, 663552
  s_add_u32 s52, s52, s53
  s_mov_b64 exec, -1
  s_add_u32 s36, s20, s52
  s_addc_u32 s37, s21, 0
  s_mov_b32 s38, 18432
  s_mov_b32 s39, 0x20000
  v_lshlrev_b32 v4, 7, v1
  v_add_u32 v5, 0x2000, v4
  v_add_u32 v6, 0x4000, v4
  buffer_load_dword v8, v4, s[36:39], 0 offen
  buffer_load_dword v8, v5, s[36:39], 0 offen
  buffer_load_dword v8, v6, s[36:39], 0 offen
  s_branch L_fin
noF_95:
  s_cmp_ge_u32 s2, 108
  s_cbranch_scc1 L_fin
  s_cmp_lg_u32 s3, 0
  s_cbranch_scc1 L_fin
  s_sub_u32 s52, s2, 72
  s_mul_i32 s58, s52, 9216
  s_add_u32 s58, s58, 737280
  s_lshl_b32 s59, s52, 6
  s_mul_i32 s52, s54, 18432
  s_add_u32 s59, s59, s52
  s_add_u32 s59, s59, 589824
  v_lshrrev_b32 v6, 2, v1
  v_mul_u32_u24 v6, 2304, v6
  v_and_b32 v9, 3, v1
  v_lshl_add_u32 v6, v9, 4, v6
  v_mov_b32 v8, 2147483632
  v_cndmask_b32 v9, v8, v23, s[44:45]
  v_cmp_gt_u32 vcc, 32, v1
  v_lshlrev_b32 v247, 16, v247
  s_nop 0
  v_cndmask_b32 v6, v8, v6, vcc
  v_lshlrev_b32 v10, 4, v1
  s_lshl_b32 s60, s54, 10
  s_add_u32 s61, s60, 1286144
  s_add_u32 s60, s60, 1277952
  s_add_u32 s96, s58, 4096
  s_add_u32 s97, s58, 8192
  s_getreg_b32 s60, hwreg(HW_REG_XCC_ID, 0, 3)
  s_lshl_b32 s60, s60, 10
  s_add_u32 s60, s60, 1286144
  s_movk_i32 s61, 120
  v_lshlrev_b32 v14, 3, v1
lh_109:
  buffer_load_dwordx2 v[12:13], v14, s[28:31], s60 offen offset:512 sc1
  s_sub_u32 s61, s61, 1
  s_cbranch_scc1 lhd_110
  s_waitcnt vmcnt(0)
  v_cmp_eq_u32 vcc, v12, v16
  v_cmp_eq_u32 s[46:47], v13, v16
  s_bcnt1_i32_b64 s52, vcc
  s_bcnt1_i32_b64 s53, s[46:47]
  s_add_u32 s52, s52, s53
  s_cmp_lt_u32 s52, 14
  s_cbranch_scc1 lh_109
lhd_110:
  s_mov_b64 exec, -1
  s_waitcnt vmcnt(0)
  buffer_load_dwordx4 v[12:15], v6, s[28:31], s59 offen sc0 sc1
  buffer_load_dwordx4 v[106:109], v10, s[28:31], s58 offen offset:0 sc0 sc1
  buffer_load_dwordx4 v[110:113], v10, s[28:31], s58 offen offset:1024 sc0 sc1
  buffer_load_dwordx4 v[114:117], v10, s[28:31], s58 offen offset:2048 sc0 sc1
  buffer_load_dwordx4 v[118:121], v10, s[28:31], s58 offen offset:3072 sc0 sc1
  buffer_load_dwordx4 v[122:125], v10, s[28:31], s96 offen offset:0 sc0 sc1
  buffer_load_dwordx4 v[126:129], v10, s[28:31], s96 offen offset:1024 sc0 sc1
  buffer_load_dwordx4 v[130:133], v10, s[28:31], s96 offen offset:2048 sc0 sc1
  buffer_load_dwordx4 v[134:137], v10, s[28:31], s96 offen offset:3072 sc0 sc1
  buffer_load_dwordx4 v[138:141], v10, s[28:31], s97 offen offset:0 sc0 sc1
  s_waitcnt vmcnt(9)
  s_branch h4w_111
h4_106:
  buffer_load_dwordx4 v[12:15], v6, s[28:31], s59 offen sc0 sc1
  s_waitcnt vmcnt(0)
h4w_111:
  v_pk_add_f32 v[4:5], v[12:13], v[14:15]
  v_cmp_u_f32 vcc, v4, v5
  s_cbranch_vccz h4d_107
  s_mov_b64 exec, vcc
  s_sub_u32 s62, s62, 1
  s_cbranch_scc1 L_end
  s_and_b32 s52, s62, 63
  s_cbranch_scc1 h4_106
  v_max_u32 v4, v12, v13
  v_max3_u32 v4, v4, v14, v15
  v_cmp_eq_u32 vcc, -1, v4
  s_cbranch_vccz h4d_107
  s_mov_b64 exec, vcc
  s_sub_u32 s62, s62, 1
  s_cbranch_scc1 L_end
  s_branch h4_106
h4d_107:
  s_mov_b64 exec, -1
  v_permlane32_swap_b32 v12, v13
  v_permlane32_swap_b32 v14, v15
  v_add_f32 v12, v12, v13
  v_add_f32 v14, v14, v15
  s_nop 1
  v_permlane16_swap_b32 v12, v14
  v_add_f32 v12, v12, v14
  s_nop 1
  v_add_f32_dpp v12, v12, v12 row_ror:8 row_mask:0xf bank_mask:0xf
  s_nop 1
  v_add_f32_dpp v12, v12, v12 row_ror:4 row_mask:0xf bank_mask:0xf
  v_cvt_pk_bf16_f32 v12, v12, v12
  v_and_b32 v12, 0xffff0000, v12
  v_add_f32 v11, v12, v247
  v_cvt_pk_bf16_f32 v11, v11, v11
  v_and_b32 v11, 0xffff0000, v11
  s_branch h3w_108
h3_104:
  buffer_load_dwordx4 v[106:109], v10, s[28:31], s58 offen offset:0 sc0 sc1
  buffer_load_dwordx4 v[110:113], v10, s[28:31], s58 offen offset:1024 sc0 sc1
  buffer_load_dwordx4 v[114:117], v10, s[28:31], s58 offen offset:2048 sc0 sc1
  buffer_load_dwordx4 v[118:121], v10, s[28:31], s58 offen offset:3072 sc0 sc1
  buffer_load_dwordx4 v[122:125], v10, s[28:31], s96 offen offset:0 sc0 sc1
  buffer_load_dwordx4 v[126:129], v10, s[28:31], s96 offen offset:1024 sc0 sc1
  buffer_load_dwordx4 v[130:133], v10, s[28:31], s96 offen offset:2048 sc0 sc1
  buffer_load_dwordx4 v[134:137], v10, s[28:31], s96 offen offset:3072 sc0 sc1
  buffer_load_dwordx4 v[138:141], v10, s[28:31], s97 offen offset:0 sc0 sc1
h3w_108:
  s_waitcnt vmcnt(7)
  v_pk_add_f32 v[12:13], v[106:107], v[110:111]
  v_pk_add_f32 v[14:15], v[108:109], v[112:113]
  s_waitcnt vmcnt(6)
  v_pk_add_f32 v[12:13], v[12:13], v[114:115]
  v_pk_add_f32 v[14:15], v[14:15], v[116:117]
  s_waitcnt vmcnt(5)
  v_pk_add_f32 v[12:13], v[12:13], v[118:119]
  v_pk_add_f32 v[14:15], v[14:15], v[120:121]
  s_waitcnt vmcnt(4)
  v_pk_add_f32 v[12:13], v[12:13], v[122:123]
  v_pk_add_f32 v[14:15], v[14:15], v[124:125]
  s_waitcnt vmcnt(3)
  v_pk_add_f32 v[12:13], v[12:13], v[126:127]
  v_pk_add_f32 v[14:15], v[14:15], v[128:129]
  s_waitcnt vmcnt(2)
  v_pk_add_f32 v[12:13], v[12:13], v[130:131]
  v_pk_add_f32 v[14:15], v[14:15], v[132:133]
  s_waitcnt vmcnt(1)
  v_pk_add_f32 v[12:13], v[12:13], v[134:135]
  v_pk_add_f32 v[14:15], v[14:15], v[136:137]
  s_waitcnt vmcnt(0)
  v_pk_add_f32 v[12:13], v[12:13], v[138:139]
  v_pk_add_f32 v[14:15], v[14:15], v[140:141]
  v_pk_add_f32 v[4:5], v[12:13], v[14:15]
  v_cmp_u_f32 vcc, v4, v5
  s_cbranch_vccz h3d_105
  s_mov_b64 exec, vcc
  s_sub_u32 s62, s62, 1
  s_cbranch_scc1 L_end
  s_and_b32 s52, s62, 63
  s_cbranch_scc1 h3_104
  v_max_u32 v4, v106, v107
  v_max3_u32 v4, v4, v108, v109
  v_max3_u32 v4, v4, v110, v111
  v_max3_u32 v4, v4, v112, v113
  v_max3_u32 v4, v4, v114, v115
  v_max3_u32 v4, v4, v116, v117
  v_max3_u32 v4, v4, v118, v119
  v_max3_u32 v4, v4, v120, v121
  v_max3_u32 v4, v4, v122, v123
  v_max3_u32 v4, v4, v124, v125
  v_max3_u32 v4, v4, v126, v127
  v_max3_u32 v4, v4, v128, v129
  v_max3_u32 v4, v4, v130, v131
  v_max3_u32 v4, v4, v132, v133
  v_max3_u32 v4, v4, v134, v135
  v_max3_u32 v4, v4, v136, v137
  v_max3_u32 v4, v4, v138, v139
  v_max3_u32 v4, v4, v140, v141
  v_cmp_eq_u32 vcc, -1, v4
  s_cbranch_vccz h3d_105
  s_mov_b64 exec, vcc
  s_sub_u32 s62, s62, 1
  s_cbranch_scc1 L_end
  s_branch h3_104
h3d_105:
  s_mov_b64 exec, -1
  v_permlane32_swap_b32 v12, v13
  v_permlane32_swap_b32 v14, v15
  v_add_f32 v12, v12, v13
  v_add_f32 v14, v14, v15
  s_nop 1
  v_permlane16_swap_b32 v12, v14
  v_add_f32 v12, v12, v14
  s_nop 1
  v_add_f32_dpp v12, v12, v12 row_ror:8 row_mask:0xf bank_mask:0xf
  s_nop 1
  v_add_f32_dpp v12, v12, v12 row_ror:4 row_mask:0xf bank_mask:0xf
  v_cvt_pk_bf16_f32 v12, v12, v12
  v_and_b32 v12, 0xffff0000, v12
  v_add_f32 v12, v12, v11
  v_cvt_pk_bf16_f32 v12, v12, v12
  buffer_store_short v12, v9, s[40:43], 0 offen
  s_branch L_fin
noO_94:
  v_mul_u32_u24 v10, 2304, v2
  v_lshl_add_u32 v10, v3, 4, v10
  v_mov_b32 v9, 2147483632
  v_cndmask_b32 v11, v9, v10, s[44:45]
  s_mul_i32 s52, s3, 576
  s_mul_i32 s96, s54, 18432
  s_add_u32 s96, s96, s52
  s_add_u32 s96, s96, 589824
  s_add_u32 s97, s96, 9216
  s_lshl_b32 s58, s56, 6
  s_mul_i32 s53, s3, 82944
  s_add_u32 s58, s58, s53
  s_add_u32 s58, s58, 737280
  s_mul_i32 s52, s3, 288
  v_lshl_add_u32 v51, v17, 1, s52
  v_add_u32 v51, 158016, v51
  s_lshl_b32 s53, s3, 3
  s_add_u32 s53, s53, 157952
  v_mov_b32 v52, s53
  v_mov_b32 v53, 157952
  v_lshlrev_b32 v55, 4, v2
  v_add_u32 v54, 158016, v55
  v_mul_u32_u24 v57, 9216, v3
  v_add_u32 v57, v57, v55
  v_add_u32 v55, 161472, v55
  v_cmp_gt_u32 vcc, 9, v3
  v_lshrrev_b32 v12, 2, v3
  v_lshl_add_u32 v12, v2, 3, v12
  v_cndmask_b32 v57, v9, v57, vcc
  v_mul_u32_u24 v8, 1152, v12
  v_and_b32 v6, 3, v3
  v_lshl_add_u32 v8, v6, 3, v8
  v_add_u32 v8, 106496, v8
  v_lshrrev_b32 v14, 3, v3
  v_lshlrev_b32 v15, 1, v2
  v_and_b32 v15, 2, v15
  v_or_b32 v14, v14, v15
  v_and_b32 v56, 1, v2
  v_lshl_add_u32 v56, v56, 2, v6
  s_lshl_b32 s52, s3, 4
  s_add_u32 s53, s52, 161472
  v_lshl_add_u32 v56, v56, 1, s53
  v_lshlrev_b32 v12, 6, v12
  v_and_b32 v13, 1, v3
  v_lshl_add_u32 v12, v13, 3, v12
  v_and_b32 v15, 2, v3
  v_and_b32 v13, 1, v2
  v_or_b32 v13, v13, v15
  v_xor_b32 v13, s3, v13
  v_lshl_add_u32 v12, v13, 4, v12
  v_mul_u32_u24 v15, 18432, v15
  v_add_u32 v12, 32768, v12
  v_add_u32 v6, v12, v15
  v_lshlrev_b32 v18, 16, v18
  v_lshlrev_b32 v19, 16, v19
  v_lshlrev_b32 v20, 16, v20
  s_waitcnt vmcnt(0)
  v_mov_b32 v50, v6
  s_mul_i32 s52, s3, 9
  s_lshl_b32 s60, s54, 10
  s_add_u32 s60, s60, 1277952
  s_mul_i32 s52, s56, 36864
  s_add_u32 s36, s20, s52
  s_addc_u32 s37, s21, 0
  s_mov_b32 s38, 36864
  s_mov_b32 s39, 0x20000
  s_mul_i32 s60, s3, 288
  s_mul_i32 s59, s3, 9216
  s_add_u32 s59, s59, 106496
  v_add_u32 v12, 0, v1
  v_mul_u32_u24 v13, 3641, v12
  v_lshrrev_b32 v13, 16, v13
  v_mul_u32_u24 v14, 18, v13
  v_sub_u32 v14, v12, v14
  v_mul_u32_u24 v13, 1152, v13
  v_lshl_add_u32 v24, v14, 4, v13
  v_add_u32 v12, 64, v1
  v_mul_u32_u24 v13, 3641, v12
  v_lshrrev_b32 v13, 16, v13
  v_mul_u32_u24 v14, 18, v13
  v_sub_u32 v14, v12, v14
  v_mul_u32_u24 v13, 1152, v13
  v_lshl_add_u32 v25, v14, 4, v13
  v_subrev_u32 v25, 1024, v25
  v_add_u32 v12, 128, v1
  v_mul_u32_u24 v13, 3641, v12
  v_lshrrev_b32 v13, 16, v13
  v_mul_u32_u24 v14, 18, v13
  v_sub_u32 v14, v12, v14
  v_mul_u32_u24 v13, 1152, v13
  v_lshl_add_u32 v26, v14, 4, v13
  v_subrev_u32 v26, 2048, v26
  v_add_u32 v12, 192, v1
  v_mul_u32_u24 v13, 3641, v12
  v_lshrrev_b32 v13, 16, v13
  v_mul_u32_u24 v14, 18, v13
  v_sub_u32 v14, v12, v14
  v_mul_u32_u24 v13, 1152, v13
  v_lshl_add_u32 v27, v14, 4, v13
  v_subrev_u32 v27, 3072, v27
  v_add_u32 v12, 256, v1
  v_mul_u32_u24 v13, 3641, v12
  v_lshrrev_b32 v13, 16, v13
  v_mul_u32_u24 v14, 18, v13
  v_sub_u32 v14, v12, v14
  v_mul_u32_u24 v13, 1152, v13
  v_lshl_add_u32 v28, v14, 4, v13
  v_add_u32 v12, 320, v1
  v_mul_u32_u24 v13, 3641, v12
  v_lshrrev_b32 v13, 16, v13
  v_mul_u32_u24 v14, 18, v13
  v_sub_u32 v14, v12, v14
  v_mul_u32_u24 v13, 1152, v13
  v_lshl_add_u32 v29, v14, 4, v13
  v_subrev_u32 v29, 1024, v29
  v_add_u32 v12, 384, v1
  v_mul_u32_u24 v13, 3641, v12
  v_lshrrev_b32 v13, 16, v13
  v_mul_u32_u24 v14, 18, v13
  v_sub_u32 v14, v12, v14
  v_mul_u32_u24 v13, 1152, v13
  v_lshl_add_u32 v30, v14, 4, v13
  v_subrev_u32 v30, 2048, v30
  v_add_u32 v12, 448, v1
  v_mul_u32_u24 v13, 3641, v12
  v_lshrrev_b32 v13, 16, v13
  v_mul_u32_u24 v14, 18, v13
  v_sub_u32 v14, v12, v14
  v_mul_u32_u24 v13, 1152, v13
  v_lshl_add_u32 v31, v14, 4, v13
  v_subrev_u32 v31, 3072, v31
  v_add_u32 v12, 512, v1
  v_mul_u32_u24 v13, 3641, v12
  v_lshrrev_b32 v13, 16, v13
  v_mul_u32_u24 v14, 18, v13
  v_sub_u32 v14, v12, v14
  v_mul_u32_u24 v13, 1152, v13
  v_lshl_add_u32 v32, v14, 4, v13
  v_lshrrev_b32 v12, 1, v2
  v_lshlrev_b32 v12, 4, v12
  v_and_b32 v13, 1, v2
  v_lshl_add_u32 v12, v13, 2, v12
  v_lshrrev_b32 v14, 2, v3
  v_add_u32 v12, v12, v14
  v_mul_u32_u24 v12, 288, v12
  v_and_b32 v14, 3, v3
  v_lshl_add_u32 v12, v14, 3, v12
  v_add_u32 v33, s59, v12
  s_lshr_b32 s52, s3, 1
  s_lshl_b32 s52, s52, 5
  s_and_b32 s53, s3, 1
  s_lshl_b32 s53, s53, 3
  s_add_u32 s52, s52, s53
  s_add_u32 s52, s52, 161472
  v_lshl_add_u32 v13, v13, 3, v14
  v_lshl_add_u32 v56, v13, 1, s52
spin_115:
  ds_read_b32 v4, v45 offset:8
  s_waitcnt lgkmcnt(0)
  v_readfirstlane_b32 s52, v4
  s_nop 0
  s_cmp_ge_i32 s52, 4
  s_cbranch_scc1 done_116
  s_sub_u32 s62, s62, 1
  s_cbranch_scc1 L_end
  s_branch spin_115
done_116:
  s_movk_i32 s61, 258
spin_117:
  ds_read_b32 v4, v21 offset:0
  s_waitcnt lgkmcnt(0)
  v_readfirstlane_b32 s52, v4
  s_nop 0
  s_cmp_ge_i32 s52, s61
  s_cbranch_scc1 done_118
  s_sub_u32 s62, s62, 1
  s_cbranch_scc1 L_end
  s_branch spin_117
done_118:
  s_getreg_b32 s63, hwreg(HW_REG_XCC_ID, 0, 3)
  s_lshl_b32 s63, s63, 10
  s_add_u32 s63, s63, 1277952
  s_movk_i32 s61, 100
  v_lshlrev_b32 v13, 2, v1
  buffer_load_dword v12, v13, s[28:31], s63 offen sc1
  ds_read_b64_tr_b16 v[184:185], v50 offset:0
  ds_read_b64_tr_b16 v[186:187], v50 offset:256
  ds_read_b64_tr_b16 v[188:189], v50 offset:2048
  ds_read_b64_tr_b16 v[190:191], v50 offset:2304
  ds_read_b64_tr_b16 v[192:193], v50 offset:4096
  ds_read_b64_tr_b16 v[194:195], v50 offset:4352
  ds_read_b64_tr_b16 v[196:197], v50 offset:6144
  ds_read_b64_tr_b16 v[198:199], v50 offset:6400
  ds_read_b64_tr_b16 v[200:201], v50 offset:8192
  ds_read_b64_tr_b16 v[202:203], v50 offset:8448
  ds_read_b64_tr_b16 v[204:205], v50 offset:10240
  ds_read_b64_tr_b16 v[206:207], v50 offset:10496
  ds_read_b64_tr_b16 v[208:209], v50 offset:12288
  ds_read_b64_tr_b16 v[210:211], v50 offset:12544
  ds_read_b64_tr_b16 v[212:213], v50 offset:14336
  ds_read_b64_tr_b16 v[214:215], v50 offset:14592
  ds_read_b64_tr_b16 v[216:217], v50 offset:16384
  ds_read_b64_tr_b16 v[218:219], v50 offset:16640
  ds_read_b64_tr_b16 v[220:221], v50 offset:18432
  ds_read_b64_tr_b16 v[222:223], v50 offset:18688
  ds_read_b64_tr_b16 v[224:225], v50 offset:20480
  ds_read_b64_tr_b16 v[226:227], v50 offset:20736
  ds_read_b64_tr_b16 v[228:229], v50 offset:22528
  ds_read_b64_tr_b16 v[230:231], v50 offset:22784
  ds_read_b64_tr_b16 v[232:233], v50 offset:24576
  ds_read_b64_tr_b16 v[234:235], v50 offset:24832
  ds_read_b64_tr_b16 v[236:237], v50 offset:26624
  ds_read_b64_tr_b16 v[238:239], v50 offset:26880
  ds_read_b64_tr_b16 v[240:241], v50 offset:28672
  ds_read_b64_tr_b16 v[242:243], v50 offset:28928
  ds_read_b64_tr_b16 v[244:245], v50 offset:30720
  ds_read_b64_tr_b16 v[246:247], v50 offset:30976
  ds_read_b64_tr_b16 v[248:249], v50 offset:32768
  ds_read_b64_tr_b16 v[250:251], v50 offset:33024
  ds_read_b64_tr_b16 v[252:253], v50 offset:34816
  ds_read_b64_tr_b16 v[254:255], v50 offset:35072
  s_branch lhc_121
lh_119:
  buffer_load_dword v12, v13, s[28:31], s63 offen sc1
lhc_121:
  s_sub_u32 s61, s61, 1
  s_cbranch_scc1 lhd_120
  s_waitcnt vmcnt(0)
  v_cmp_eq_u32 vcc, v12, v16
  s_nop 0
  s_bcnt1_i32_b64 s52, vcc
  s_cmp_lt_u32 s52, 7
  s_cbranch_scc1 lh_119
lhd_120:
  s_mov_b64 exec, -1
  buffer_load_dwordx4 v[106:109], v10, s[28:31], s96 offen offset:0 sc0 sc1
  buffer_load_dwordx4 v[110:113], v10, s[28:31], s97 offen offset:0 sc0 sc1
  buffer_load_dwordx4 v[114:117], v10, s[28:31], s96 offen offset:256 sc0 sc1
  buffer_load_dwordx4 v[118:121], v10, s[28:31], s97 offen offset:256 sc0 sc1
  buffer_load_dwordx4 v[122:125], v11, s[28:31], s96 offen offset:512 sc0 sc1
  buffer_load_dwordx4 v[126:129], v11, s[28:31], s97 offen offset:512 sc0 sc1
  s_branch h2w_114
h2_112:
  buffer_load_dwordx4 v[106:109], v10, s[28:31], s96 offen offset:0 sc0 sc1
  buffer_load_dwordx4 v[110:113], v10, s[28:31], s97 offen offset:0 sc0 sc1
  buffer_load_dwordx4 v[114:117], v10, s[28:31], s96 offen offset:256 sc0 sc1
  buffer_load_dwordx4 v[118:121], v10, s[28:31], s97 offen offset:256 sc0 sc1
  buffer_load_dwordx4 v[122:125], v11, s[28:31], s96 offen offset:512 sc0 sc1
  buffer_load_dwordx4 v[126:129], v11, s[28:31], s97 offen offset:512 sc0 sc1
h2w_114:
  s_waitcnt vmcnt(4)
  v_pk_add_f32 v[156:157], v[106:107], v[110:111]
  v_pk_add_f32 v[158:159], v[108:109], v[112:113]
  s_waitcnt vmcnt(2)
  v_pk_add_f32 v[160:161], v[114:115], v[118:119]
  v_pk_add_f32 v[162:163], v[116:117], v[120:121]
  s_waitcnt vmcnt(0)
  v_pk_add_f32 v[164:165], v[122:123], v[126:127]
  v_pk_add_f32 v[166:167], v[124:125], v[128:129]
  v_pk_add_f32 v[4:5], v[156:157], v[158:159]
  v_pk_add_f32 v[4:5], v[4:5], v[160:161]
  v_pk_add_f32 v[4:5], v[4:5], v[162:163]
  v_pk_add_f32 v[4:5], v[4:5], v[164:165]
  v_pk_add_f32 v[4:5], v[4:5], v[166:167]
  v_cmp_u_f32 vcc, v4, v5
  s_cbranch_vccz h2d_113
  s_mov_b64 exec, vcc
  s_sub_u32 s62, s62, 1
  s_cbranch_scc1 L_end
  s_and_b32 s52, s62, 63
  s_cbranch_scc1 h2_112
  v_max_u32 v4, v106, v107
  v_max3_u32 v4, v4, v108, v109
  v_max3_u32 v4, v4, v110, v111
  v_max3_u32 v4, v4, v112, v113
  v_max3_u32 v4, v4, v114, v115
  v_max3_u32 v4, v4, v116, v117
  v_max3_u32 v4, v4, v118, v119
  v_max3_u32 v4, v4, v120, v121
  v_max3_u32 v4, v4, v122, v123
  v_max3_u32 v4, v4, v124, v125
  v_max3_u32 v4, v4, v126, v127
  v_max3_u32 v4, v4, v128, v129
  v_cmp_eq_u32 vcc, -1, v4
  s_cbranch_vccz h2d_113
  s_mov_b64 exec, vcc
  s_sub_u32 s62, s62, 1
  s_cbranch_scc1 L_end
  s_branch h2_112
h2d_113:
  s_mov_b64 exec, -1
  s_mov_b32 m0, s59
  s_add_u32 s59, s59, 4096
  buffer_load_dwordx4 v24, s[36:39], s60 offen offset:0  lds
  buffer_load_dwordx4 v25, s[36:39], s60 offen offset:1024  lds
  buffer_load_dwordx4 v26, s[36:39], s60 offen offset:2048  lds
  buffer_load_dwordx4 v27, s[36:39], s60 offen offset:3072  lds
  s_mov_b32 m0, s59
  s_add_u32 s59, s59, 4096
  buffer_load_dwordx4 v28, s[36:39], s60 offen offset:0  lds
  buffer_load_dwordx4 v29, s[36:39], s60 offen offset:1024  lds
  buffer_load_dwordx4 v30, s[36:39], s60 offen offset:2048  lds
  buffer_load_dwordx4 v31, s[36:39], s60 offen offset:3072  lds
  s_mov_b32 m0, s59
  s_add_u32 s59, s59, 4096
  buffer_load_dwordx4 v32, s[36:39], s60 offen offset:0  lds
  v_permlane32_swap_b32 v156, v157
  v_permlane32_swap_b32 v158, v159
  v_permlane32_swap_b32 v160, v161
  v_permlane32_swap_b32 v162, v163
  v_permlane32_swap_b32 v164, v165
  v_permlane32_swap_b32 v166, v167
  v_add_f32 v156, v156, v157
  v_add_f32 v158, v158, v159
  v_add_f32 v160, v160, v161
  v_add_f32 v162, v162, v163
  v_add_f32 v164, v164, v165
  v_add_f32 v166, v166, v167
  v_permlane16_swap_b32 v156, v158
  v_permlane16_swap_b32 v160, v162
  v_permlane16_swap_b32 v164, v166
  v_add_f32 v156, v156, v158
  v_add_f32 v160, v160, v162
  v_add_f32 v164, v164, v166
  v_cvt_pk_bf16_f32 v4, v156, v160
  v_lshlrev_b32 v156, 16, v4
  v_and_b32 v160, 0xffff0000, v4
  v_cvt_pk_bf16_f32 v164, v164, v164
  v_and_b32 v164, 0xffff0000, v164
  v_add_f32 v156, v156, v18
  v_add_f32 v160, v160, v19
  v_add_f32 v164, v164, v20
  v_cvt_pk_bf16_f32 v4, v156, v160
  v_lshlrev_b32 v156, 16, v4
  v_and_b32 v160, 0xffff0000, v4
  v_cvt_pk_bf16_f32 v164, v164, v164
  v_and_b32 v164, 0xffff0000, v164
  v_readfirstlane_b32 s53, v156
  s_nop 1
  v_subrev_f32 v8, s53, v156
  v_subrev_f32 v9, s53, v160
  v_subrev_f32 v10, s53, v164
  v_mul_f32 v5, v8, v8
  v_add_f32 v4, v8, v9
  v_cndmask_b32 v10, v7, v10, s[44:45]
  v_fmac_f32 v5, v9, v9
  v_add_f32 v4, v4, v10
  v_fmac_f32 v5, v10, v10
  s_nop 0
  v_add_f32_dpp v4, v4, v4 row_ror:8 row_mask:0xf bank_mask:0xf
  v_add_f32_dpp v5, v5, v5 row_ror:8 row_mask:0xf bank_mask:0xf
  s_nop 0
  v_add_f32_dpp v4, v4, v4 row_ror:4 row_mask:0xf bank_mask:0xf
  v_add_f32_dpp v5, v5, v5 row_ror:4 row_mask:0xf bank_mask:0xf
  s_nop 0
  v_add_f32_dpp v4, v4, v4 row_ror:2 row_mask:0xf bank_mask:0xf
  v_add_f32_dpp v5, v5, v5 row_ror:2 row_mask:0xf bank_mask:0xf
  s_nop 0
  v_add_f32_dpp v4, v4, v4 row_ror:1 row_mask:0xf bank_mask:0xf
  v_add_f32_dpp v5, v5, v5 row_ror:1 row_mask:0xf bank_mask:0xf
  s_nop 0
  v_add_f32_dpp v4, v4, v4 row_bcast:15 row_mask:0xa bank_mask:0xf
  v_add_f32_dpp v5, v5, v5 row_bcast:15 row_mask:0xa bank_mask:0xf
  s_nop 0
  v_add_f32_dpp v4, v4, v4 row_bcast:31 row_mask:0xc bank_mask:0xf
  v_add_f32_dpp v5, v5, v5 row_bcast:31 row_mask:0xc bank_mask:0xf
  v_readlane_b32 s46, v4, 63
  v_readlane_b32 s47, v5, 63
  v_mov_b32 v8, 0x3be38e39
  v_mul_f32 v8, s46, v8
  v_mov_b32 v9, s47
  v_fma_f32 v9, -v8, s46, v9
  v_add_f32 v8, s53, v8
  s_mov_b64 exec, 1
  ds_write_b64 v52, v[8:9]
  s_mov_b64 exec, -1
  s_waitcnt lgkmcnt(0)
  s_barrier
  ds_read_b128 v[106:109], v53
  ds_read_b128 v[110:113], v53 offset:16
  s_waitcnt lgkmcnt(0)
  v_pk_add_f32 v[8:9], v[106:107], v[108:109]
  v_pk_add_f32 v[10:11], v[110:111], v[112:113]
  v_pk_add_f32 v[8:9], v[8:9], v[10:11]
  v_mul_f32 v8, 0x3e800000, v8
  v_sub_f32 v106, v106, v8
  v_sub_f32 v108, v108, v8
  v_sub_f32 v110, v110, v8
  v_sub_f32 v112, v112, v8
  v_mul_f32 v10, v106, v106
  v_fmac_f32 v10, v108, v108
  v_fmac_f32 v10, v110, v110
  v_fmac_f32 v10, v112, v112
  v_fmac_f32 v9, 0x43100000, v10
  v_mul_f32 v9, 0x3ae38e39, v9
  v_cvt_pk_bf16_f32 v10, v8, v9
  v_lshlrev_b32 v8, 16, v10
  v_and_b32 v9, 0xffff0000, v10
  v_add_f32 v9, 0x3727c5ac, v9
  v_cvt_pk_bf16_f32 v9, v9, v9
  v_and_b32 v9, 0xffff0000, v9
  v_sqrt_f32 v9, v9
  s_nop 0
  v_cvt_pk_bf16_f32 v9, v9, v9
  v_and_b32 v9, 0xffff0000, v9
  v_rcp_f32 v9, v9
  v_sub_f32 v156, v156, v8
  v_sub_f32 v160, v160, v8
  v_sub_f32 v164, v164, v8
  v_cvt_pk_bf16_f32 v4, v156, v160
  v_lshlrev_b32 v156, 16, v4
  v_and_b32 v160, 0xffff0000, v4
  v_cvt_pk_bf16_f32 v164, v164, v164
  v_and_b32 v164, 0xffff0000, v164
  v_mul_f32 v156, v156, v9
  v_mul_f32 v160, v160, v9
  v_mul_f32 v164, v164, v9
  v_cvt_pk_bf16_f32 v12, v156, v160
  v_cvt_pk_bf16_f32 v13, v164, v164
  ds_write_b16 v51, v12
  ds_write_b16_d16_hi v51, v12 offset:128
  s_mov_b64 exec, s[44:45]
  ds_write_b16 v51, v13 offset:256
  s_mov_b32 s46, 0x22222222
  s_mov_b32 s47, 0x22222222
  s_mov_b32 s48, 0xcccccccc
  s_mov_b32 s49, 0xcccccccc
  s_mov_b32 s50, 0x88888888
  s_mov_b32 s51, 0x88888888
  s_mov_b64 exec, -1
  s_mov_b64 exec, -1
  s_waitcnt lgkmcnt(0)
  s_barrier
  ds_read_b128 v[106:109], v54 offset:0
  ds_read_b128 v[110:113], v54 offset:64
  ds_read_b128 v[114:117], v54 offset:128
  ds_read_b128 v[118:121], v54 offset:192
  ds_read_b128 v[122:125], v54 offset:256
  ds_read_b128 v[126:129], v54 offset:320
  ds_read_b128 v[130:133], v54 offset:384
  ds_read_b128 v[134:137], v54 offset:448
  ds_read_b128 v[138:141], v54 offset:512
  ds_read_b128 v[142:145], v54 offset:576
  ds_read_b128 v[146:149], v54 offset:640
  ds_read_b128 v[150:153], v54 offset:704
  ds_read_b128 v[154:157], v54 offset:768
  ds_read_b128 v[158:161], v54 offset:832
  ds_read_b128 v[162:165], v54 offset:896
  ds_read_b128 v[166:169], v54 offset:960
  ds_read_b128 v[170:173], v54 offset:1024
  ds_read_b128 v[174:177], v54 offset:1088
  v_mov_b32 v6, 0x3d372713
  s_waitcnt lgkmcnt(15)
  v_mfma_f32_16x16x32_bf16 v[12:15], v[184:187], v[106:109], 0
  s_waitcnt lgkmcnt(15)
  v_mfma_f32_16x16x32_bf16 v[8:11], v[188:191], v[110:113], 0
  s_waitcnt lgkmcnt(15)
  v_mfma_f32_16x16x32_bf16 v[12:15], v[192:195], v[114:117], v[12:15]
  s_waitcnt lgkmcnt(14)
  v_mfma_f32_16x16x32_bf16 v[8:11], v[196:199], v[118:121], v[8:11]
  s_waitcnt lgkmcnt(13)
  v_mfma_f32_16x16x32_bf16 v[12:15], v[200:203], v[122:125], v[12:15]
  s_waitcnt lgkmcnt(12)
  v_mfma_f32_16x16x32_bf16 v[8:11], v[204:207], v[126:129], v[8:11]
  s_waitcnt lgkmcnt(11)
  v_mfma_f32_16x16x32_bf16 v[12:15], v[208:211], v[130:133], v[12:15]
  s_waitcnt lgkmcnt(10)
  v_mfma_f32_16x16x32_bf16 v[8:11], v[212:215], v[134:137], v[8:11]
  s_waitcnt lgkmcnt(9)
  v_mfma_f32_16x16x32_bf16 v[12:15], v[216:219], v[138:141], v[12:15]
  s_waitcnt lgkmcnt(8)
  v_mfma_f32_16x16x32_bf16 v[8:11], v[220:223], v[142:145], v[8:11]
  s_waitcnt lgkmcnt(7)
  v_mfma_f32_16x16x32_bf16 v[12:15], v[224:227], v[146:149], v[12:15]
  s_waitcnt lgkmcnt(6)
  v_mfma_f32_16x16x32_bf16 v[8:11], v[228:231], v[150:153], v[8:11]
  s_waitcnt lgkmcnt(5)
  v_mfma_f32_16x16x32_bf16 v[12:15], v[232:235], v[154:157], v[12:15]
  s_waitcnt lgkmcnt(4)
  v_mfma_f32_16x16x32_bf16 v[8:11], v[236:239], v[158:161], v[8:11]
  s_waitcnt lgkmcnt(3)
  v_mfma_f32_16x16x32_bf16 v[12:15], v[240:243], v[162:165], v[12:15]
  s_waitcnt lgkmcnt(2)
  v_mfma_f32_16x16x32_bf16 v[8:11], v[244:247], v[166:169], v[8:11]
  s_waitcnt lgkmcnt(1)
  v_mfma_f32_16x16x32_bf16 v[12:15], v[248:251], v[170:173], v[12:15]
  s_waitcnt lgkmcnt(0)
  v_mfma_f32_16x16x32_bf16 v[8:11], v[252:255], v[174:177], v[8:11]
  s_nop 7
  v_pk_add_f32 v[12:13], v[12:13], v[8:9]
  v_pk_add_f32 v[14:15], v[14:15], v[10:11]
  v_cndmask_b32 v12, v12, v13, s[46:47]
  v_cndmask_b32 v14, v14, v15, s[50:51]
  v_cndmask_b32 v12, v12, v14, s[48:49]
  v_cvt_pk_bf16_f32 v12, v12, v12
  v_and_b32 v12, 0xffff0000, v12
  v_mov_b32 v13, v12
  s_nop 1
  v_permlane32_swap_b32 v12, v13
  v_mul_f32 v8, v12, v12
  v_mul_f32 v8, v8, v12
  v_fma_f32 v8, v8, v6, v12
  v_mul_f32 v8, 0xc0135761, v8
  v_exp_f32 v8, v8
  s_nop 0
  v_add_f32 v8, 1.0, v8
  v_rcp_f32 v8, v8
  s_nop 0
  v_mul_f32 v12, v12, v8
  v_cvt_pk_bf16_f32 v12, v12, v12
  v_and_b32 v12, 0xffff0000, v12
  v_mul_f32 v12, v12, v13
  v_cvt_pk_bf16_f32 v12, v12, v12
  s_mov_b64 exec, 0x000f000f
  ds_write_b16 v56, v12
  s_mov_b32 s46, 0x00010001
  s_mov_b32 s47, 0x00010001
  s_mov_b64 exec, -1
  s_waitcnt vmcnt(0)
  ds_read_b64_tr_b16 v[58:59], v33 offset:0
  ds_read_b64_tr_b16 v[60:61], v33 offset:2304
  ds_read_b64_tr_b16 v[62:63], v33 offset:32
  ds_read_b64_tr_b16 v[64:65], v33 offset:2336
  ds_read_b64_tr_b16 v[66:67], v33 offset:64
  ds_read_b64_tr_b16 v[68:69], v33 offset:2368
  ds_read_b64_tr_b16 v[70:71], v33 offset:96
  ds_read_b64_tr_b16 v[72:73], v33 offset:2400
  ds_read_b64_tr_b16 v[74:75], v33 offset:128
  ds_read_b64_tr_b16 v[76:77], v33 offset:2432
  ds_read_b64_tr_b16 v[78:79], v33 offset:160
  ds_read_b64_tr_b16 v[80:81], v33 offset:2464
  ds_read_b64_tr_b16 v[82:83], v33 offset:192
  ds_read_b64_tr_b16 v[84:85], v33 offset:2496
  ds_read_b64_tr_b16 v[86:87], v33 offset:224
  ds_read_b64_tr_b16 v[88:89], v33 offset:2528
  ds_read_b64_tr_b16 v[90:91], v33 offset:256
  ds_read_b64_tr_b16 v[92:93], v33 offset:2560
  s_mov_b64 exec, -1
  s_waitcnt lgkmcnt(0)
  s_barrier
  ds_read_b128 v[12:15], v55
  s_waitcnt lgkmcnt(0)
  v_mfma_f32_16x16x32_bf16 v[94:97], v[58:61], v[12:15], 0
  v_mfma_f32_16x16x32_bf16 v[110:113], v[62:65], v[12:15], 0
  v_mfma_f32_16x16x32_bf16 v[114:117], v[66:69], v[12:15], 0
  v_mfma_f32_16x16x32_bf16 v[118:121], v[70:73], v[12:15], 0
  v_mfma_f32_16x16x32_bf16 v[122:125], v[74:77], v[12:15], 0
  v_mfma_f32_16x16x32_bf16 v[126:129], v[78:81], v[12:15], 0
  v_mfma_f32_16x16x32_bf16 v[130:133], v[82:85], v[12:15], 0
  v_mfma_f32_16x16x32_bf16 v[134:137], v[86:89], v[12:15], 0
  v_mfma_f32_16x16x32_bf16 v[138:141], v[90:93], v[12:15], 0
  s_lshl_b64 exec, s[46:47], 1
  v_pk_mov_b32 v[94:95], v[110:111], v[110:111] op_sel:[0,1]
  v_pk_mov_b32 v[96:97], v[112:113], v[112:113] op_sel:[0,1]
  s_lshl_b64 exec, s[46:47], 2
  v_pk_mov_b32 v[94:95], v[114:115], v[114:115] op_sel:[0,1]
  v_pk_mov_b32 v[96:97], v[116:117], v[116:117] op_sel:[0,1]
  s_lshl_b64 exec, s[46:47], 3
  v_pk_mov_b32 v[94:95], v[118:119], v[118:119] op_sel:[0,1]
  v_pk_mov_b32 v[96:97], v[120:121], v[120:121] op_sel:[0,1]
  s_lshl_b64 exec, s[46:47], 4
  v_pk_mov_b32 v[94:95], v[122:123], v[122:123] op_sel:[0,1]
  v_pk_mov_b32 v[96:97], v[124:125], v[124:125] op_sel:[0,1]
  s_lshl_b64 exec, s[46:47], 5
  v_pk_mov_b32 v[94:95], v[126:127], v[126:127] op_sel:[0,1]
  v_pk_mov_b32 v[96:97], v[128:129], v[128:129] op_sel:[0,1]
  s_lshl_b64 exec, s[46:47], 6
  v_pk_mov_b32 v[94:95], v[130:131], v[130:131] op_sel:[0,1]
  v_pk_mov_b32 v[96:97], v[132:133], v[132:133] op_sel:[0,1]
  s_lshl_b64 exec, s[46:47], 7
  v_pk_mov_b32 v[94:95], v[134:135], v[134:135] op_sel:[0,1]
  v_pk_mov_b32 v[96:97], v[136:137], v[136:137] op_sel:[0,1]
  s_lshl_b64 exec, s[46:47], 8
  v_pk_mov_b32 v[94:95], v[138:139], v[138:139] op_sel:[0,1]
  v_pk_mov_b32 v[96:97], v[140:141], v[140:141] op_sel:[0,1]
  s_mov_b64 exec, -1
  v_min_u32 v94, -2, v94
  v_min_u32 v95, -2, v95
  v_min_u32 v96, -2, v96
  v_min_u32 v97, -2, v97
  buffer_store_dwordx4 v[94:97], v57, s[28:31], s58 offen sc0 sc1
  s_cmp_lg_u32 s3, 0
  s_cbranch_scc1 L_fin
  s_getreg_b32 s52, hwreg(HW_REG_XCC_ID, 0, 3)
  s_lshl_b32 s52, s52, 10
  s_lshl_b32 s53, s2, 2
  s_add_u32 s52, s52, s53
  s_add_u32 s52, s52, 1286144
  s_mov_b64 exec, 1
  buffer_store_dword v16, v7, s[28:31], s52 offen
L_fin:
L_end:
  s_endpgm
.section .rodata,"a"
.p2align 6
.amdhsa_kernel sequential_preLN__gqa_block_cached__geglu_ffn__decode_kernel
.amdhsa_next_free_vgpr 256
.amdhsa_next_free_sgpr 102
.amdhsa_accum_offset 256
.amdhsa_group_segment_fixed_size 0
.amdhsa_kernarg_size 96
.amdhsa_user_sgpr_count 2
.amdhsa_user_sgpr_kernarg_segment_ptr 1
.amdhsa_system_sgpr_workgroup_id_x 1
.amdhsa_float_denorm_mode_32 3
.end_amdhsa_kernel
```
